```python
import torch

def _softmax(x, axis=-1):
    return torch.softmax(x, dim=axis)

def _gelu(x):
    return torch.nn.functional.gelu(x, approximate='tanh')

def _silu(x):
    return torch.nn.functional.silu(x)

def _sigmoid(x):
    return torch.sigmoid(x)

def _layernorm(x, axis=-1, eps=1e-05):
    m = x.mean(dim=axis, keepdim=True)
    v = x.var(dim=axis, keepdim=True, unbiased=False)
    return (x - m) / torch.sqrt(v + eps)

def _scatter_add(tgt, idx, src, axis=0):
    return tgt.clone().index_add_(axis, idx, src)

def _segment_sum(src, seg, n):
    out = torch.zeros((n,) + src.shape[1:], dtype=src.dtype)
    return out.index_add_(0, seg, src)

def _pad(x, pw):
    flat = tuple((v for pair in reversed(pw) for v in pair))
    return torch.nn.functional.pad(x, flat)
kernel_name = 'standalone__conformer_conv_module__speech'

def setup_inputs():

    _w = lambda a: (lambda t: t.to(torch.bfloat16) if t.is_floating_point() else t)(torch.as_tensor(a))
    B, T, D, K = (2, 16000, 256, 3)
    return {'x': _w((lambda *s: torch.randn(*s, dtype=torch.bfloat16) * 0.2)(B, T, D)), 'w_pw1': _w((lambda *s: torch.randn(*s, dtype=torch.bfloat16) * 0.2)(D, 2 * D)), 'dw': _w((lambda *s: torch.randn(*s, dtype=torch.bfloat16) * 0.2)(K, D)), 'w_pw2': _w((lambda *s: torch.randn(*s, dtype=torch.bfloat16) * 0.05)(D, D))}

def reference(x, w_pw1, dw, w_pw2):
    B, T, D = x.shape
    K = dw.shape[0]
    h = x @ w_pw1
    a, b = (h[..., :D].clone(), h[..., D:].clone())
    h = a * _sigmoid(b)
    pad = K // 2
    hp = _pad(h, ((0, 0), (pad, pad), (0, 0)))
    out = torch.zeros_like(h)
    for i in range(K):
        out = out + hp[:, i:i + T, :] * dw[i][None, None, :]
    return _silu(out) @ w_pw2
```

```asm
; @launch grid=(256,1,1) block=(512,1,1) lds=163840
.amdgcn_target "amdgcn-amd-amdhsa--gfx950"
.text
.globl standalone__conformer_conv_module__speech_kernel
.p2align 8
.type standalone__conformer_conv_module__speech_kernel,@function
standalone__conformer_conv_module__speech_kernel:
s_cmp_ge_u32 s2, 256
s_cbranch_scc1 L_done
s_load_dwordx4 s[4:7], s[0:1], 0
v_readfirstlane_b32 s28, v0
v_and_b32 v19, 3, v0
v_bfe_u32 v21, v0, 4, 2
v_bfe_u32 v20, v0, 2, 2
s_mul_i32 s3, s2, 45
s_lshr_b32 s3, s3, 3
s_and_b32 s3, s3, 7
s_lshr_b32 s28, s28, 6
s_and_b32 s29, s28, 3
s_mov_b32 s11, 0x20000
s_cmp_lt_u32 s28, 4
s_cbranch_scc1 L_e0
s_setprio 3
s_getpc_b64 s[40:41]
L_pc:
s_getreg_b32 s47, hwreg(HW_REG_HW_ID, 8, 3)
v_and_b32 v30, 63, v0
s_lshl_b32 s37, s47, 2
s_add_u32 s37, s37, s29
s_lshl_b32 s37, s37, 7
v_lshl_add_u32 v30, v30, 12, s37
v_mov_b32 v29, s41
v_add_co_u32 v28, vcc, s40, v30
s_mov_b32 s42, L_done-L_pc
s_nop 0
v_addc_co_u32 v29, vcc, 0, v29, vcc
v_cmp_gt_u32 vcc, s42, v30
s_nop 1
s_mov_b64 exec, vcc
global_load_dword v4, v[28:29], off
s_mov_b64 exec, -1
L_e0:
s_and_b32 s38, s28, 4
s_add_u32 s38, s38, s28
s_add_u32 s34, s38, 8
s_lshl_b32 s34, s34, 12
v_lshl_add_u32 v20, s38, 2, v20
v_lshl_add_u32 v22, v21, 2, v19
s_lshl_b32 s37, s3, 1
s_and_b32 s32, s37, 8
s_and_b32 s37, s37, 6
s_and_b32 s35, s28, 1
s_add_u32 s37, s37, s35
s_lshl_b32 s37, s37, 1
v_xor_b32 v22, s37, v22
s_xor_b32 s33, s32, 8
s_lshl_b32 s32, s32, 5
s_lshl_b32 s33, s33, 5
s_lshr_b32 s38, s2, 7
s_lshl_b32 s37, s38, 7
s_sub_u32 s37, s2, s37
s_mulk_i32 s37, 125
s_add_u32 s37, s37, 62
v_sub_u32 v21, s37, v20
v_add3_u32 v20, v20, s37, 1
v_lshl_add_u32 v56, v21, 5, v22
v_xor_b32 v22, 1, v22
v_lshl_add_u32 v57, v20, 5, v22
v_lshlrev_b32 v56, 4, v56
v_lshlrev_b32 v57, 4, v57
s_mov_b32 s10, 8192000
s_mul_i32 s46, s38, s10
v_add_u32 v60, -8192, v56
v_add_u32 v61, 8192, v57
s_cmp_ge_u32 s28, 4
s_cbranch_scc1 L_e1
v_bfe_u32 v20, v0, 2, 4
v_lshl_add_u32 v20, v20, 6, v19
v_lshlrev_b32 v9, 4, v20
s_and_b32 s37, s28, 2
s_lshl_b32 s37, s37, 1
s_add_u32 s37, s35, s37
s_lshl_b32 m0, s37, 14
s_lshl_b32 s37, s3, 15
s_lshl_b32 s39, s28, 6
s_sub_u32 s14, 262144, s39
s_mov_b32 s15, s11
s_waitcnt lgkmcnt(0)
s_add_u32 s12, s6, s39
s_addc_u32 s13, s7, 0
buffer_load_dwordx4 v9, s[12:15], s37 offen lds
s_addk_i32 m0, 512
s_nop 0
buffer_load_dwordx4 v9, s[12:15], s37 offen offset:512 lds
s_addk_i32 m0, 1536
s_addk_i32 s37, 16384
buffer_load_dwordx4 v9, s[12:15], s37 offen lds
s_addk_i32 m0, 512
s_nop 0
buffer_load_dwordx4 v9, s[12:15], s37 offen offset:512 lds
s_mov_b32 m0, s34
s_add_u32 s8, s4, s46
s_addc_u32 s9, s5, 0
buffer_load_dwordx4 v56, s[8:11], s32 offen nt lds
s_addk_i32 m0, 1024
s_nop 0
buffer_load_dwordx4 v56, s[8:11], s33 offen nt lds
s_addk_i32 m0, 1024
s_nop 0
buffer_load_dwordx4 v57, s[8:11], s32 offen nt lds
s_addk_i32 m0, 1024
s_nop 0
buffer_load_dwordx4 v57, s[8:11], s33 offen nt lds
s_addk_i32 m0, 13312
s_nop 0
buffer_load_dwordx4 v60, s[8:11], s32 offen nt lds
s_addk_i32 m0, 1024
s_nop 0
buffer_load_dwordx4 v60, s[8:11], s33 offen nt lds
s_addk_i32 m0, 1024
s_nop 0
buffer_load_dwordx4 v61, s[8:11], s32 offen nt lds
s_addk_i32 m0, 1024
s_nop 0
buffer_load_dwordx4 v61, s[8:11], s33 offen nt lds
L_e1:
s_load_dwordx2 s[24:25], s[0:1], 16
s_load_dwordx2 s[16:17], s[0:1], 24
s_load_dwordx2 s[20:21], s[0:1], 32
v_and_b32 v16, 63, v0
v_and_b32 v17, 31, v0
v_bfe_u32 v18, v0, 5, 1
v_lshrrev_b32 v20, 2, v16
v_lshl_add_u32 v20, v20, 6, v19
v_lshlrev_b32 v9, 4, v20
s_lshl_b32 s30, s3, 15
s_and_b32 s37, s28, 2
s_lshl_b32 s37, s37, 1
s_add_u32 s35, s35, s37
s_add_u32 s36, s29, 6
s_cmp_ge_u32 s28, 4
s_cselect_b32 s35, s36, s35
s_lshl_b32 s35, s35, 14
s_lshl_b32 s36, s36, 14
s_lshl_b32 s39, s28, 6
s_sub_u32 s14, 262144, s39
s_mov_b32 s15, s11
v_mov_b32 v8, 0xbfb8aa3b
v_bfe_u32 v23, v16, 4, 1
v_bfe_u32 v24, v16, 2, 2
v_and_b32 v25, 3, v16
v_lshrrev_b32 v19, 2, v17
v_xor_b32 v20, v18, v24
v_lshlrev_b32 v20, 4, v20
v_lshl_add_u32 v20, v25, 6, v20
v_add_u32 v19, 16, v19
v_lshl_add_u32 v0, v19, 11, v20
v_xor_b32 v1, 32, v0
v_lshl_add_u32 v19, v18, 3, v24
v_lshl_add_u32 v19, v19, 1, v23
v_lshl_add_u32 v19, v19, 2, v25
v_lshl_add_u32 v10, v19, 3, s35
s_lshl_b32 s37, s28, 1
s_xor_b32 s37, s37, s3
s_lshl_b32 s37, s37, 4
v_xor_b32 v19, s37, v17
v_bfe_u32 v21, v17, 1, 2
v_lshlrev_b32 v22, 1, v18
v_xor_b32 v21, v21, v22
v_lshl_add_u32 v19, v19, 2, v21
v_lshlrev_b32 v2, 4, v19
v_xor_b32 v15, 16, v2
s_mov_b32 vcc_lo, 0
s_mov_b32 vcc_hi, -1
s_waitcnt lgkmcnt(0)
s_add_u32 s8, s4, s46
s_addc_u32 s9, s5, 0
s_add_u32 s12, s6, s39
s_addc_u32 s13, s7, 0
s_lshl_b32 s39, s28, 6
v_lshl_add_u32 v6, v17, 1, s39
v_lshl_add_u32 v7, v18, 10, v6
v_xor_b32 v5, 1024, v7
s_mov_b32 s26, 1536
s_mov_b32 s27, 0x20000
buffer_load_ushort v6, v6, s[24:27], 0 offen offset:512
buffer_load_ushort v7, v7, s[24:27], 0 offen
buffer_load_ushort v5, v5, s[24:27], 0 offen
s_cmp_ge_u32 s28, 4
s_cbranch_scc1 L_e3
s_add_u32 m0, s35, 4096
s_xor_b32 s37, s30, 32768
buffer_load_dwordx4 v9, s[12:15], s37 offen lds
s_add_u32 m0, s35, 4608
s_nop 0
buffer_load_dwordx4 v9, s[12:15], s37 offen offset:512 lds
s_add_u32 m0, s35, 6144
s_xor_b32 s37, s30, 49152
buffer_load_dwordx4 v9, s[12:15], s37 offen lds
s_add_u32 m0, s35, 6656
s_nop 0
buffer_load_dwordx4 v9, s[12:15], s37 offen offset:512 lds
s_add_u32 m0, s35, 8192
s_xor_b32 s37, s30, 65536
buffer_load_dwordx4 v9, s[12:15], s37 offen lds
s_add_u32 m0, s35, 8704
s_nop 0
buffer_load_dwordx4 v9, s[12:15], s37 offen offset:512 lds
s_add_u32 m0, s35, 10240
s_xor_b32 s37, s30, 81920
buffer_load_dwordx4 v9, s[12:15], s37 offen lds
s_add_u32 m0, s35, 10752
s_nop 0
buffer_load_dwordx4 v9, s[12:15], s37 offen offset:512 lds
s_add_u32 m0, s35, 12288
s_xor_b32 s37, s30, 98304
buffer_load_dwordx4 v9, s[12:15], s37 offen lds
s_add_u32 m0, s35, 12800
s_nop 0
buffer_load_dwordx4 v9, s[12:15], s37 offen offset:512 lds
s_add_u32 m0, s35, 14336
s_xor_b32 s37, s30, 114688
buffer_load_dwordx4 v9, s[12:15], s37 offen lds
s_add_u32 m0, s35, 14848
s_nop 0
buffer_load_dwordx4 v9, s[12:15], s37 offen offset:512 lds
s_waitcnt vmcnt(15)
L_e3:
L_e2:
s_barrier
s_cmp_ge_u32 s28, 4
s_cbranch_scc1 L_grp_b
s_setprio 3
ds_read_b64_tr_b16 v[128:129], v10 offset:0
ds_read_b64_tr_b16 v[130:131], v10 offset:256
ds_read_b64_tr_b16 v[192:193], v10 offset:1024
ds_read_b64_tr_b16 v[194:195], v10 offset:1280
ds_read_b128 v[32:35], v0 offset:0
ds_read_b128 v[36:39], v0 offset:16384
ds_read_b64_tr_b16 v[132:133], v10 offset:2048
ds_read_b64_tr_b16 v[134:135], v10 offset:2304
ds_read_b64_tr_b16 v[196:197], v10 offset:3072
ds_read_b64_tr_b16 v[198:199], v10 offset:3328
ds_read_b128 v[40:43], v1 offset:0
ds_read_b128 v[44:47], v1 offset:16384
s_waitcnt lgkmcnt(6)
v_mfma_f32_32x32x16_bf16 v[80:95], v[32:35], v[192:195], 0
s_add_u32 m0, s35, 0
s_xor_b32 s37, s30, 131072
buffer_load_dwordx4 v9, s[12:15], s37 offen lds
s_add_u32 m0, s35, 512
v_mfma_f32_32x32x16_bf16 v[64:79], v[32:35], v[128:131], 0
s_waitcnt vmcnt(12)
ds_read_b64_tr_b16 v[136:137], v10 offset:4096
ds_read_b64_tr_b16 v[138:139], v10 offset:4352
ds_read_b128 v[48:51], v0 offset:256
v_mfma_f32_32x32x16_bf16 v[112:127], v[36:39], v[192:195], 0
buffer_load_dwordx4 v9, s[12:15], s37 offen offset:512 lds
v_mfma_f32_32x32x16_bf16 v[96:111], v[36:39], v[128:131], 0
s_waitcnt vmcnt(12)
ds_read_b64_tr_b16 v[200:201], v10 offset:5120
ds_read_b64_tr_b16 v[202:203], v10 offset:5376
ds_read_b128 v[52:55], v0 offset:16640
s_waitcnt lgkmcnt(6)
v_mfma_f32_32x32x16_bf16 v[80:95], v[40:43], v[196:199], v[80:95]
s_add_u32 m0, s35, 2048
s_xor_b32 s37, s30, 147456
buffer_load_dwordx4 v9, s[12:15], s37 offen lds
s_add_u32 m0, s35, 2560
v_mfma_f32_32x32x16_bf16 v[64:79], v[40:43], v[132:135], v[64:79]
s_waitcnt vmcnt(12)
ds_read_b64_tr_b16 v[140:141], v10 offset:6144
ds_read_b64_tr_b16 v[142:143], v10 offset:6400
ds_read_b128 v[32:35], v1 offset:256
v_mfma_f32_32x32x16_bf16 v[112:127], v[44:47], v[196:199], v[112:127]
buffer_load_dwordx4 v9, s[12:15], s37 offen offset:512 lds
v_mfma_f32_32x32x16_bf16 v[96:111], v[44:47], v[132:135], v[96:111]
s_waitcnt vmcnt(12)
ds_read_b64_tr_b16 v[204:205], v10 offset:7168
ds_read_b64_tr_b16 v[206:207], v10 offset:7424
ds_read_b128 v[36:39], v1 offset:16640
s_waitcnt lgkmcnt(6)
v_mfma_f32_32x32x16_bf16 v[80:95], v[48:51], v[200:203], v[80:95]
s_add_u32 m0, s35, 4096
s_xor_b32 s37, s30, 163840
buffer_load_dwordx4 v9, s[12:15], s37 offen lds
s_add_u32 m0, s35, 4608
v_mfma_f32_32x32x16_bf16 v[64:79], v[48:51], v[136:139], v[64:79]
s_waitcnt vmcnt(12)
ds_read_b64_tr_b16 v[144:145], v10 offset:8192
ds_read_b64_tr_b16 v[146:147], v10 offset:8448
ds_read_b128 v[40:43], v0 offset:512
v_mfma_f32_32x32x16_bf16 v[112:127], v[52:55], v[200:203], v[112:127]
buffer_load_dwordx4 v9, s[12:15], s37 offen offset:512 lds
v_mfma_f32_32x32x16_bf16 v[96:111], v[52:55], v[136:139], v[96:111]
s_waitcnt vmcnt(12)
ds_read_b64_tr_b16 v[208:209], v10 offset:9216
ds_read_b64_tr_b16 v[210:211], v10 offset:9472
ds_read_b128 v[44:47], v0 offset:16896
s_waitcnt lgkmcnt(6)
v_mfma_f32_32x32x16_bf16 v[80:95], v[32:35], v[204:207], v[80:95]
s_add_u32 m0, s35, 6144
s_xor_b32 s37, s30, 180224
buffer_load_dwordx4 v9, s[12:15], s37 offen lds
s_add_u32 m0, s35, 6656
v_mfma_f32_32x32x16_bf16 v[64:79], v[32:35], v[140:143], v[64:79]
s_waitcnt vmcnt(12)
ds_read_b64_tr_b16 v[148:149], v10 offset:10240
ds_read_b64_tr_b16 v[150:151], v10 offset:10496
ds_read_b128 v[48:51], v1 offset:512
v_mfma_f32_32x32x16_bf16 v[112:127], v[36:39], v[204:207], v[112:127]
buffer_load_dwordx4 v9, s[12:15], s37 offen offset:512 lds
v_mfma_f32_32x32x16_bf16 v[96:111], v[36:39], v[140:143], v[96:111]
s_waitcnt vmcnt(12)
ds_read_b64_tr_b16 v[212:213], v10 offset:11264
ds_read_b64_tr_b16 v[214:215], v10 offset:11520
ds_read_b128 v[52:55], v1 offset:16896
s_waitcnt lgkmcnt(6)
v_mfma_f32_32x32x16_bf16 v[80:95], v[40:43], v[208:211], v[80:95]
s_add_u32 m0, s35, 8192
s_xor_b32 s37, s30, 196608
buffer_load_dwordx4 v9, s[12:15], s37 offen lds
s_add_u32 m0, s35, 8704
v_mfma_f32_32x32x16_bf16 v[64:79], v[40:43], v[144:147], v[64:79]
s_waitcnt vmcnt(12)
ds_read_b64_tr_b16 v[152:153], v10 offset:12288
ds_read_b64_tr_b16 v[154:155], v10 offset:12544
ds_read_b128 v[32:35], v0 offset:768
v_mfma_f32_32x32x16_bf16 v[112:127], v[44:47], v[208:211], v[112:127]
buffer_load_dwordx4 v9, s[12:15], s37 offen offset:512 lds
v_mfma_f32_32x32x16_bf16 v[96:111], v[44:47], v[144:147], v[96:111]
s_waitcnt vmcnt(12)
ds_read_b64_tr_b16 v[216:217], v10 offset:13312
ds_read_b64_tr_b16 v[218:219], v10 offset:13568
ds_read_b128 v[36:39], v0 offset:17152
s_waitcnt lgkmcnt(6)
v_mfma_f32_32x32x16_bf16 v[80:95], v[48:51], v[212:215], v[80:95]
s_add_u32 m0, s35, 10240
s_xor_b32 s37, s30, 212992
buffer_load_dwordx4 v9, s[12:15], s37 offen lds
s_add_u32 m0, s35, 10752
v_mfma_f32_32x32x16_bf16 v[64:79], v[48:51], v[148:151], v[64:79]
s_waitcnt vmcnt(12)
ds_read_b64_tr_b16 v[156:157], v10 offset:14336
ds_read_b64_tr_b16 v[158:159], v10 offset:14592
ds_read_b128 v[40:43], v1 offset:768
v_mfma_f32_32x32x16_bf16 v[112:127], v[52:55], v[212:215], v[112:127]
buffer_load_dwordx4 v9, s[12:15], s37 offen offset:512 lds
v_mfma_f32_32x32x16_bf16 v[96:111], v[52:55], v[148:151], v[96:111]
s_waitcnt vmcnt(12)
ds_read_b64_tr_b16 v[220:221], v10 offset:15360
ds_read_b64_tr_b16 v[222:223], v10 offset:15616
ds_read_b128 v[44:47], v1 offset:17152
s_waitcnt lgkmcnt(6)
v_mfma_f32_32x32x16_bf16 v[80:95], v[32:35], v[216:219], v[80:95]
s_add_u32 m0, s35, 12288
s_xor_b32 s37, s30, 229376
buffer_load_dwordx4 v9, s[12:15], s37 offen lds
s_add_u32 m0, s35, 12800
v_mfma_f32_32x32x16_bf16 v[64:79], v[32:35], v[152:155], v[64:79]
s_waitcnt vmcnt(12)
ds_read_b64_tr_b16 v[160:161], v10 offset:0
ds_read_b64_tr_b16 v[162:163], v10 offset:256
ds_read_b128 v[48:51], v0 offset:1024
v_mfma_f32_32x32x16_bf16 v[112:127], v[36:39], v[216:219], v[112:127]
buffer_load_dwordx4 v9, s[12:15], s37 offen offset:512 lds
v_mfma_f32_32x32x16_bf16 v[96:111], v[36:39], v[152:155], v[96:111]
s_waitcnt vmcnt(12)
ds_read_b64_tr_b16 v[224:225], v10 offset:1024
ds_read_b64_tr_b16 v[226:227], v10 offset:1280
ds_read_b128 v[52:55], v0 offset:17408
s_waitcnt lgkmcnt(6)
v_mfma_f32_32x32x16_bf16 v[80:95], v[40:43], v[220:223], v[80:95]
s_add_u32 m0, s35, 14336
s_xor_b32 s37, s30, 245760
buffer_load_dwordx4 v9, s[12:15], s37 offen lds
s_add_u32 m0, s35, 14848
v_mfma_f32_32x32x16_bf16 v[64:79], v[40:43], v[156:159], v[64:79]
s_waitcnt vmcnt(12)
ds_read_b64_tr_b16 v[164:165], v10 offset:2048
ds_read_b64_tr_b16 v[166:167], v10 offset:2304
ds_read_b128 v[32:35], v1 offset:1024
v_mfma_f32_32x32x16_bf16 v[112:127], v[44:47], v[220:223], v[112:127]
buffer_load_dwordx4 v9, s[12:15], s37 offen offset:512 lds
s_barrier
v_mfma_f32_32x32x16_bf16 v[96:111], v[44:47], v[156:159], v[96:111]
s_waitcnt vmcnt(12)
ds_read_b64_tr_b16 v[228:229], v10 offset:3072
ds_read_b64_tr_b16 v[230:231], v10 offset:3328
ds_read_b128 v[36:39], v1 offset:17408
s_waitcnt lgkmcnt(6)
v_mfma_f32_32x32x16_bf16 v[80:95], v[48:51], v[224:227], v[80:95]
v_lshlrev_b32 v5, 16, v5
v_lshlrev_b32 v6, 16, v6
v_lshlrev_b32 v7, 16, v7
v_mul_f32 v5, v8, v5
v_mul_f32 v6, v8, v6
v_mul_f32 v7, v8, v7
v_mfma_f32_32x32x16_bf16 v[64:79], v[48:51], v[160:163], v[64:79]
s_waitcnt vmcnt(11)
ds_read_b64_tr_b16 v[168:169], v10 offset:4096
ds_read_b64_tr_b16 v[170:171], v10 offset:4352
ds_read_b128 v[40:43], v0 offset:1280
v_mfma_f32_32x32x16_bf16 v[112:127], v[52:55], v[224:227], v[112:127]
v_mfma_f32_32x32x16_bf16 v[96:111], v[52:55], v[160:163], v[96:111]
s_waitcnt vmcnt(10)
ds_read_b64_tr_b16 v[232:233], v10 offset:5120
ds_read_b64_tr_b16 v[234:235], v10 offset:5376
ds_read_b128 v[44:47], v0 offset:17664
s_waitcnt lgkmcnt(6)
v_mfma_f32_32x32x16_bf16 v[80:95], v[32:35], v[228:231], v[80:95]
s_lshl_b32 s31, s3, 13
s_lshl_b32 s39, s29, 7
s_add_u32 s16, s16, s39
s_addc_u32 s17, s17, 0
s_sub_u32 s18, 131072, s39
v_mfma_f32_32x32x16_bf16 v[64:79], v[32:35], v[164:167], v[64:79]
s_waitcnt vmcnt(9)
ds_read_b64_tr_b16 v[172:173], v10 offset:6144
ds_read_b64_tr_b16 v[174:175], v10 offset:6400
ds_read_b128 v[48:51], v1 offset:1280
v_mfma_f32_32x32x16_bf16 v[112:127], v[36:39], v[228:231], v[112:127]
s_mov_b32 s19, 0x20000
v_lshrrev_b32 v19, 2, v17
v_lshl_add_u32 v19, v19, 3, v18
v_lshl_add_u32 v19, v19, 2, v25
v_lshlrev_b32 v58, 4, v19
v_mfma_f32_32x32x16_bf16 v[96:111], v[36:39], v[164:167], v[96:111]
s_waitcnt vmcnt(8)
ds_read_b64_tr_b16 v[236:237], v10 offset:7168
ds_read_b64_tr_b16 v[238:239], v10 offset:7424
ds_read_b128 v[52:55], v1 offset:17664
s_waitcnt lgkmcnt(6)
v_mfma_f32_32x32x16_bf16 v[80:95], v[40:43], v[232:235], v[80:95]
s_mul_i32 s38, s2, 64000
s_add_u32 s20, s20, s38
s_addc_u32 s21, s21, 0
s_mov_b32 s22, 64000
s_mov_b32 s23, 0x20000
v_mfma_f32_32x32x16_bf16 v[64:79], v[40:43], v[168:171], v[64:79]
s_waitcnt vmcnt(7)
ds_read_b64_tr_b16 v[176:177], v10 offset:8192
ds_read_b64_tr_b16 v[178:179], v10 offset:8448
ds_read_b128 v[32:35], v0 offset:1536
v_mfma_f32_32x32x16_bf16 v[112:127], v[44:47], v[232:235], v[112:127]
v_lshl_add_u32 v19, v18, 2, v24
v_lshrrev_b32 v20, 1, v25
v_lshl_add_u32 v20, v23, 1, v20
v_and_b32 v21, 1, v25
v_lshl_add_u32 v26, v19, 1, v21
v_mfma_f32_32x32x16_bf16 v[96:111], v[44:47], v[168:171], v[96:111]
s_waitcnt vmcnt(6)
ds_read_b64_tr_b16 v[240:241], v10 offset:9216
ds_read_b64_tr_b16 v[242:243], v10 offset:9472
ds_read_b128 v[36:39], v0 offset:17920
s_waitcnt lgkmcnt(6)
v_mfma_f32_32x32x16_bf16 v[80:95], v[48:51], v[236:239], v[80:95]
v_lshl_add_u32 v26, v26, 2, v20
v_lshl_add_u32 v59, v26, 3, s36
v_lshrrev_b32 v26, 1, v19
v_xor_b32 v20, v20, v26
v_lshl_add_u32 v19, v19, 2, v20
v_mfma_f32_32x32x16_bf16 v[64:79], v[48:51], v[172:175], v[64:79]
s_waitcnt vmcnt(5)
ds_read_b64_tr_b16 v[180:181], v10 offset:10240
ds_read_b64_tr_b16 v[182:183], v10 offset:10496
ds_read_b128 v[40:43], v1 offset:1536
v_mfma_f32_32x32x16_bf16 v[112:127], v[52:55], v[236:239], v[112:127]
v_lshl_add_u32 v19, v19, 1, v21
v_lshlrev_b32 v11, 3, v19
v_sub_u32 v19, 1, v23
v_mul_u32_u24 v19, 15, v19
v_xor_b32 v19, v19, v17
v_mfma_f32_32x32x16_bf16 v[96:111], v[52:55], v[172:175], v[96:111]
s_waitcnt vmcnt(4)
ds_read_b64_tr_b16 v[244:245], v10 offset:11264
ds_read_b64_tr_b16 v[246:247], v10 offset:11520
ds_read_b128 v[44:47], v1 offset:17920
s_waitcnt lgkmcnt(6)
v_mfma_f32_32x32x16_bf16 v[80:95], v[32:35], v[240:243], v[80:95]
v_and_b32 v21, 7, v19
v_xor_b32 v21, v21, v22
v_lshl_add_u32 v19, v19, 3, v21
v_lshl_add_u32 v12, v19, 4, s36
v_lshrrev_b32 v19, 3, v16
v_mfma_f32_32x32x16_bf16 v[64:79], v[32:35], v[176:179], v[64:79]
s_waitcnt vmcnt(3)
ds_read_b64_tr_b16 v[184:185], v10 offset:12288
ds_read_b64_tr_b16 v[186:187], v10 offset:12544
ds_read_b128 v[48:51], v0 offset:1792
v_mfma_f32_32x32x16_bf16 v[112:127], v[36:39], v[240:243], v[112:127]
v_xor_b32 v20, v19, v16
v_lshl_add_u32 v13, v20, 4, s36
v_and_b32 v20, 7, v16
v_lshl_add_u32 v20, v19, 5, v20
v_lshl_add_u32 v14, v20, 4, s39
v_mfma_f32_32x32x16_bf16 v[96:111], v[36:39], v[176:179], v[96:111]
s_waitcnt vmcnt(2)
ds_read_b64_tr_b16 v[248:249], v10 offset:13312
ds_read_b64_tr_b16 v[250:251], v10 offset:13568
ds_read_b128 v[52:55], v0 offset:18176
s_waitcnt lgkmcnt(6)
v_mfma_f32_32x32x16_bf16 v[80:95], v[40:43], v[244:247], v[80:95]
v_mfma_f32_32x32x16_bf16 v[64:79], v[40:43], v[180:183], v[64:79]
s_waitcnt vmcnt(1)
ds_read_b64_tr_b16 v[188:189], v10 offset:14336
ds_read_b64_tr_b16 v[190:191], v10 offset:14592
ds_read_b128 v[32:35], v1 offset:1792
v_mfma_f32_32x32x16_bf16 v[112:127], v[44:47], v[244:247], v[112:127]
v_mfma_f32_32x32x16_bf16 v[96:111], v[44:47], v[180:183], v[96:111]
s_waitcnt vmcnt(0)
ds_read_b64_tr_b16 v[252:253], v10 offset:15360
ds_read_b64_tr_b16 v[254:255], v10 offset:15616
ds_read_b128 v[36:39], v1 offset:18176
s_waitcnt lgkmcnt(6)
v_mfma_f32_32x32x16_bf16 v[80:95], v[48:51], v[248:251], v[80:95]
v_mfma_f32_32x32x16_bf16 v[64:79], v[48:51], v[184:187], v[64:79]
v_mfma_f32_32x32x16_bf16 v[112:127], v[52:55], v[248:251], v[112:127]
v_mfma_f32_32x32x16_bf16 v[96:111], v[52:55], v[184:187], v[96:111]
s_waitcnt lgkmcnt(0)
v_mfma_f32_32x32x16_bf16 v[80:95], v[32:35], v[252:255], v[80:95]
s_nop 1
v_mfma_f32_32x32x16_bf16 v[64:79], v[32:35], v[188:191], v[64:79]
s_nop 1
v_mfma_f32_32x32x16_bf16 v[112:127], v[36:39], v[252:255], v[112:127]
s_nop 1
v_mfma_f32_32x32x16_bf16 v[96:111], v[36:39], v[188:191], v[96:111]
v_mov_b32 v9, v58
v_mov_b32 v10, v59
s_setprio 0
v_mul_f32 v80, v8, v80
v_mul_f32 v81, v8, v81
v_exp_f32 v80, v80
v_exp_f32 v81, v81
v_mul_f32 v82, v8, v82
v_mul_f32 v83, v8, v83
v_add_f32 v80, 1.0, v80
v_add_f32 v81, 1.0, v81
v_exp_f32 v82, v82
v_exp_f32 v83, v83
v_rcp_f32 v80, v80
v_rcp_f32 v81, v81
v_mul_f32 v84, v8, v84
v_mul_f32 v85, v8, v85
v_mul_f32 v64, v64, v80
v_mul_f32 v65, v65, v81
v_mov_b32 v3, v64
v_mov_b32 v4, v64
v_add_f32 v82, 1.0, v82
v_add_f32 v83, 1.0, v83
v_permlane32_swap_b32 v3, v4
v_cndmask_b32 v4, v4, v3, vcc
v_mul_f32 v80, v7, v64
v_mul_f32 v81, v7, v65
v_fmac_f32 v80, v6, v4
v_fmac_f32 v81, v6, v64
v_fmac_f32 v80, v5, v3
v_fmac_f32 v81, v5, v4
v_exp_f32 v84, v84
v_exp_f32 v85, v85
v_rcp_f32 v82, v82
v_rcp_f32 v83, v83
v_exp_f32 v3, v80
v_exp_f32 v4, v81
v_mul_f32 v86, v8, v86
v_mul_f32 v87, v8, v87
v_mul_f32 v66, v66, v82
v_mul_f32 v67, v67, v83
v_add_f32 v84, 1.0, v84
v_add_f32 v85, 1.0, v85
v_mul_f32 v82, v7, v66
v_mul_f32 v83, v7, v67
v_fmac_f32 v82, v6, v65
v_fmac_f32 v83, v6, v66
v_fmac_f32 v82, v5, v64
v_fmac_f32 v83, v5, v65
v_fmaak_f32 v3, v8, v3, 0xbfb8aa3b
v_fmaak_f32 v4, v8, v4, 0xbfb8aa3b
s_barrier
v_exp_f32 v86, v86
v_exp_f32 v87, v87
v_rcp_f32 v84, v84
v_rcp_f32 v85, v85
v_exp_f32 v64, v82
v_exp_f32 v65, v83
v_rcp_f32 v3, v3
v_rcp_f32 v4, v4
v_mul_f32 v88, v8, v88
v_mul_f32 v89, v8, v89
v_mul_f32 v68, v68, v84
v_mul_f32 v69, v69, v85
v_add_f32 v86, 1.0, v86
v_add_f32 v87, 1.0, v87
v_mul_f32 v84, v7, v68
v_mul_f32 v85, v7, v69
v_fmac_f32 v84, v6, v67
v_fmac_f32 v85, v6, v68
v_fmac_f32 v84, v5, v66
v_fmac_f32 v85, v5, v67
v_fmaak_f32 v64, v8, v64, 0xbfb8aa3b
v_fmaak_f32 v65, v8, v65, 0xbfb8aa3b
v_mul_f32 v80, v80, v3
v_mul_f32 v81, v81, v4
v_exp_f32 v88, v88
v_exp_f32 v89, v89
v_rcp_f32 v86, v86
v_rcp_f32 v87, v87
v_exp_f32 v66, v84
v_exp_f32 v67, v85
v_rcp_f32 v64, v64
v_rcp_f32 v65, v65
v_cvt_pk_bf16_f32 v16, v80, v81
v_mul_f32 v90, v8, v90
v_mul_f32 v91, v8, v91
v_mul_f32 v70, v70, v86
v_mul_f32 v71, v71, v87
v_add_f32 v88, 1.0, v88
v_add_f32 v89, 1.0, v89
v_mul_f32 v86, v7, v70
v_mul_f32 v87, v7, v71
v_fmac_f32 v86, v6, v69
v_fmac_f32 v87, v6, v70
v_fmac_f32 v86, v5, v68
v_fmac_f32 v87, v5, v69
v_fmaak_f32 v66, v8, v66, 0xbfb8aa3b
v_fmaak_f32 v67, v8, v67, 0xbfb8aa3b
v_mul_f32 v82, v82, v64
v_mul_f32 v83, v83, v65
v_exp_f32 v90, v90
v_exp_f32 v91, v91
v_rcp_f32 v88, v88
v_rcp_f32 v89, v89
v_exp_f32 v68, v86
v_exp_f32 v69, v87
v_rcp_f32 v66, v66
v_rcp_f32 v67, v67
v_cvt_pk_bf16_f32 v17, v82, v83
v_mul_f32 v92, v8, v92
v_mul_f32 v93, v8, v93
v_mul_f32 v72, v72, v88
v_mul_f32 v73, v73, v89
v_add_f32 v90, 1.0, v90
v_add_f32 v91, 1.0, v91
v_mul_f32 v88, v7, v72
v_mul_f32 v89, v7, v73
v_fmac_f32 v88, v6, v71
v_fmac_f32 v89, v6, v72
v_fmac_f32 v88, v5, v70
v_fmac_f32 v89, v5, v71
v_fmaak_f32 v68, v8, v68, 0xbfb8aa3b
v_fmaak_f32 v69, v8, v69, 0xbfb8aa3b
v_mul_f32 v84, v84, v66
v_mul_f32 v85, v85, v67
v_exp_f32 v92, v92
v_exp_f32 v93, v93
v_rcp_f32 v90, v90
v_rcp_f32 v91, v91
v_exp_f32 v70, v88
v_exp_f32 v71, v89
v_rcp_f32 v68, v68
v_rcp_f32 v69, v69
v_cvt_pk_bf16_f32 v18, v84, v85
v_mul_f32 v94, v8, v94
v_mul_f32 v95, v8, v95
v_mul_f32 v74, v74, v90
v_mul_f32 v75, v75, v91
v_add_f32 v92, 1.0, v92
v_add_f32 v93, 1.0, v93
v_mul_f32 v90, v7, v74
v_mul_f32 v91, v7, v75
v_fmac_f32 v90, v6, v73
v_fmac_f32 v91, v6, v74
v_fmac_f32 v90, v5, v72
v_fmac_f32 v91, v5, v73
v_fmaak_f32 v70, v8, v70, 0xbfb8aa3b
v_fmaak_f32 v71, v8, v71, 0xbfb8aa3b
v_mul_f32 v86, v86, v68
v_mul_f32 v87, v87, v69
v_exp_f32 v94, v94
v_exp_f32 v95, v95
v_rcp_f32 v92, v92
v_rcp_f32 v93, v93
v_exp_f32 v72, v90
v_exp_f32 v73, v91
v_rcp_f32 v70, v70
v_rcp_f32 v71, v71
v_cvt_pk_bf16_f32 v19, v86, v87
v_mul_f32 v112, v8, v112
v_mul_f32 v113, v8, v113
v_mul_f32 v76, v76, v92
v_mul_f32 v77, v77, v93
v_add_f32 v94, 1.0, v94
v_add_f32 v95, 1.0, v95
v_mul_f32 v92, v7, v76
v_mul_f32 v93, v7, v77
v_fmac_f32 v92, v6, v75
v_fmac_f32 v93, v6, v76
v_fmac_f32 v92, v5, v74
v_fmac_f32 v93, v5, v75
v_fmaak_f32 v72, v8, v72, 0xbfb8aa3b
v_fmaak_f32 v73, v8, v73, 0xbfb8aa3b
v_mul_f32 v88, v88, v70
v_mul_f32 v89, v89, v71
v_exp_f32 v112, v112
v_exp_f32 v113, v113
v_rcp_f32 v94, v94
v_rcp_f32 v95, v95
v_exp_f32 v74, v92
v_exp_f32 v75, v93
v_rcp_f32 v72, v72
v_rcp_f32 v73, v73
v_cvt_pk_bf16_f32 v20, v88, v89
v_mul_f32 v114, v8, v114
v_mul_f32 v115, v8, v115
v_mul_f32 v78, v78, v94
v_mul_f32 v79, v79, v95
v_add_f32 v112, 1.0, v112
v_add_f32 v113, 1.0, v113
v_mul_f32 v94, v7, v78
v_mul_f32 v95, v7, v79
v_fmac_f32 v94, v6, v77
v_fmac_f32 v95, v6, v78
v_fmac_f32 v94, v5, v76
v_fmac_f32 v95, v5, v77
v_fmaak_f32 v74, v8, v74, 0xbfb8aa3b
v_fmaak_f32 v75, v8, v75, 0xbfb8aa3b
v_mul_f32 v90, v90, v72
v_mul_f32 v91, v91, v73
v_exp_f32 v114, v114
v_exp_f32 v115, v115
v_rcp_f32 v112, v112
v_rcp_f32 v113, v113
v_exp_f32 v76, v94
v_exp_f32 v77, v95
v_rcp_f32 v74, v74
v_rcp_f32 v75, v75
v_cvt_pk_bf16_f32 v21, v90, v91
s_setprio 1
v_mul_f32 v116, v8, v116
v_mul_f32 v117, v8, v117
v_mul_f32 v96, v96, v112
v_mul_f32 v97, v97, v113
v_add_f32 v114, 1.0, v114
v_add_f32 v115, 1.0, v115
v_mul_f32 v112, v7, v96
v_mul_f32 v113, v7, v97
v_fmac_f32 v112, v6, v79
v_fmac_f32 v113, v6, v96
v_fmac_f32 v112, v5, v78
v_fmac_f32 v113, v5, v79
v_fmaak_f32 v76, v8, v76, 0xbfb8aa3b
v_fmaak_f32 v77, v8, v77, 0xbfb8aa3b
v_mul_f32 v92, v92, v74
v_mul_f32 v93, v93, v75
v_exp_f32 v116, v116
v_exp_f32 v117, v117
v_rcp_f32 v114, v114
v_rcp_f32 v115, v115
v_exp_f32 v78, v112
v_exp_f32 v79, v113
v_rcp_f32 v76, v76
v_rcp_f32 v77, v77
v_cvt_pk_bf16_f32 v22, v92, v93
v_mul_f32 v118, v8, v118
v_mul_f32 v119, v8, v119
v_mul_f32 v98, v98, v114
v_mul_f32 v99, v99, v115
v_add_f32 v116, 1.0, v116
v_add_f32 v117, 1.0, v117
v_mul_f32 v114, v7, v98
v_mul_f32 v115, v7, v99
v_fmac_f32 v114, v6, v97
v_fmac_f32 v115, v6, v98
v_fmac_f32 v114, v5, v96
v_fmac_f32 v115, v5, v97
v_fmaak_f32 v78, v8, v78, 0xbfb8aa3b
v_fmaak_f32 v79, v8, v79, 0xbfb8aa3b
v_mul_f32 v94, v94, v76
v_mul_f32 v95, v95, v77
v_exp_f32 v118, v118
v_exp_f32 v119, v119
v_rcp_f32 v116, v116
v_rcp_f32 v117, v117
v_exp_f32 v96, v114
v_exp_f32 v97, v115
v_rcp_f32 v78, v78
v_rcp_f32 v79, v79
v_cvt_pk_bf16_f32 v23, v94, v95
v_mul_f32 v120, v8, v120
v_mul_f32 v121, v8, v121
v_mul_f32 v100, v100, v116
v_mul_f32 v101, v101, v117
v_add_f32 v118, 1.0, v118
v_add_f32 v119, 1.0, v119
v_mul_f32 v116, v7, v100
v_mul_f32 v117, v7, v101
v_fmac_f32 v116, v6, v99
v_fmac_f32 v117, v6, v100
v_fmac_f32 v116, v5, v98
v_fmac_f32 v117, v5, v99
v_fmaak_f32 v96, v8, v96, 0xbfb8aa3b
v_fmaak_f32 v97, v8, v97, 0xbfb8aa3b
v_mul_f32 v112, v112, v78
v_mul_f32 v113, v113, v79
v_exp_f32 v120, v120
v_exp_f32 v121, v121
v_rcp_f32 v118, v118
v_rcp_f32 v119, v119
v_exp_f32 v98, v116
v_exp_f32 v99, v117
v_rcp_f32 v96, v96
v_rcp_f32 v97, v97
v_cvt_pk_bf16_f32 v24, v112, v113
v_mul_f32 v122, v8, v122
v_mul_f32 v123, v8, v123
v_mul_f32 v102, v102, v118
v_mul_f32 v103, v103, v119
v_add_f32 v120, 1.0, v120
v_add_f32 v121, 1.0, v121
v_mul_f32 v118, v7, v102
v_mul_f32 v119, v7, v103
v_fmac_f32 v118, v6, v101
v_fmac_f32 v119, v6, v102
v_fmac_f32 v118, v5, v100
v_fmac_f32 v119, v5, v101
v_fmaak_f32 v98, v8, v98, 0xbfb8aa3b
v_fmaak_f32 v99, v8, v99, 0xbfb8aa3b
v_mul_f32 v114, v114, v96
v_mul_f32 v115, v115, v97
v_exp_f32 v122, v122
v_exp_f32 v123, v123
v_rcp_f32 v120, v120
v_rcp_f32 v121, v121
v_exp_f32 v100, v118
v_exp_f32 v101, v119
v_rcp_f32 v98, v98
v_rcp_f32 v99, v99
v_cvt_pk_bf16_f32 v25, v114, v115
v_mul_f32 v124, v8, v124
v_mul_f32 v125, v8, v125
v_mul_f32 v104, v104, v120
v_mul_f32 v105, v105, v121
v_add_f32 v122, 1.0, v122
v_add_f32 v123, 1.0, v123
v_mul_f32 v120, v7, v104
v_mul_f32 v121, v7, v105
v_fmac_f32 v120, v6, v103
v_fmac_f32 v121, v6, v104
v_fmac_f32 v120, v5, v102
v_fmac_f32 v121, v5, v103
v_fmaak_f32 v100, v8, v100, 0xbfb8aa3b
v_fmaak_f32 v101, v8, v101, 0xbfb8aa3b
v_mul_f32 v116, v116, v98
v_mul_f32 v117, v117, v99
v_exp_f32 v124, v124
v_exp_f32 v125, v125
v_rcp_f32 v122, v122
v_rcp_f32 v123, v123
v_exp_f32 v102, v120
v_exp_f32 v103, v121
v_rcp_f32 v100, v100
v_rcp_f32 v101, v101
v_cvt_pk_bf16_f32 v26, v116, v117
v_mul_f32 v126, v8, v126
v_mul_f32 v127, v8, v127
v_mul_f32 v106, v106, v122
v_mul_f32 v107, v107, v123
v_add_f32 v124, 1.0, v124
v_add_f32 v125, 1.0, v125
v_mul_f32 v122, v7, v106
v_mul_f32 v123, v7, v107
v_fmac_f32 v122, v6, v105
v_fmac_f32 v123, v6, v106
v_fmac_f32 v122, v5, v104
v_fmac_f32 v123, v5, v105
v_fmaak_f32 v102, v8, v102, 0xbfb8aa3b
v_fmaak_f32 v103, v8, v103, 0xbfb8aa3b
v_mul_f32 v118, v118, v100
v_mul_f32 v119, v119, v101
v_exp_f32 v126, v126
v_exp_f32 v127, v127
v_rcp_f32 v124, v124
v_rcp_f32 v125, v125
v_exp_f32 v104, v122
v_exp_f32 v105, v123
v_rcp_f32 v102, v102
v_rcp_f32 v103, v103
v_cvt_pk_bf16_f32 v27, v118, v119
v_mul_f32 v108, v108, v124
v_mul_f32 v109, v109, v125
v_add_f32 v126, 1.0, v126
v_add_f32 v127, 1.0, v127
v_mul_f32 v124, v7, v108
v_mul_f32 v125, v7, v109
v_fmac_f32 v124, v6, v107
v_fmac_f32 v125, v6, v108
v_fmac_f32 v124, v5, v106
v_fmac_f32 v125, v5, v107
v_fmaak_f32 v104, v8, v104, 0xbfb8aa3b
v_fmaak_f32 v105, v8, v105, 0xbfb8aa3b
v_mul_f32 v120, v120, v102
v_mul_f32 v121, v121, v103
v_rcp_f32 v126, v126
v_rcp_f32 v127, v127
v_exp_f32 v106, v124
v_exp_f32 v107, v125
v_rcp_f32 v104, v104
v_rcp_f32 v105, v105
v_cvt_pk_bf16_f32 v28, v120, v121
v_mul_f32 v3, v110, v126
v_mul_f32 v4, v111, v127
v_mul_f32 v126, v7, v3
v_mul_f32 v127, v7, v4
v_fmac_f32 v126, v6, v109
v_fmac_f32 v127, v6, v3
v_fmac_f32 v126, v5, v108
v_fmac_f32 v127, v5, v109
v_fmaak_f32 v106, v8, v106, 0xbfb8aa3b
v_fmaak_f32 v107, v8, v107, 0xbfb8aa3b
v_mul_f32 v122, v122, v104
v_mul_f32 v123, v123, v105
v_exp_f32 v108, v126
v_exp_f32 v109, v127
v_rcp_f32 v106, v106
v_rcp_f32 v107, v107
v_cvt_pk_bf16_f32 v29, v122, v123
v_fmaak_f32 v108, v8, v108, 0xbfb8aa3b
v_fmaak_f32 v109, v8, v109, 0xbfb8aa3b
v_mul_f32 v124, v124, v106
v_mul_f32 v125, v125, v107
v_rcp_f32 v108, v108
v_rcp_f32 v109, v109
v_cvt_pk_bf16_f32 v30, v124, v125
s_barrier
ds_read_b128 v[32:35], v0 offset:32768
ds_read_b128 v[36:39], v0 offset:49152
ds_read_b128 v[40:43], v1 offset:32768
ds_read_b128 v[44:47], v1 offset:49152
v_mul_f32 v126, v126, v108
v_mul_f32 v127, v127, v109
v_cvt_pk_bf16_f32 v31, v126, v127
s_setprio 3
s_waitcnt lgkmcnt(3)
v_mfma_f32_32x32x16_bf16 v[80:95], v[32:35], v[192:195], 0
v_mfma_f32_32x32x16_bf16 v[64:79], v[32:35], v[128:131], 0
ds_read_b128 v[48:51], v0 offset:33024
s_waitcnt lgkmcnt(3)
v_mfma_f32_32x32x16_bf16 v[112:127], v[36:39], v[192:195], 0
v_mfma_f32_32x32x16_bf16 v[96:111], v[36:39], v[128:131], 0
ds_read_b128 v[52:55], v0 offset:49408
s_waitcnt lgkmcnt(3)
v_mfma_f32_32x32x16_bf16 v[80:95], v[40:43], v[196:199], v[80:95]
v_mfma_f32_32x32x16_bf16 v[64:79], v[40:43], v[132:135], v[64:79]
ds_read_b128 v[32:35], v1 offset:33024
s_waitcnt lgkmcnt(3)
v_mfma_f32_32x32x16_bf16 v[112:127], v[44:47], v[196:199], v[112:127]
v_mfma_f32_32x32x16_bf16 v[96:111], v[44:47], v[132:135], v[96:111]
ds_read_b128 v[36:39], v1 offset:49408
s_waitcnt lgkmcnt(3)
v_mfma_f32_32x32x16_bf16 v[80:95], v[48:51], v[200:203], v[80:95]
v_mfma_f32_32x32x16_bf16 v[64:79], v[48:51], v[136:139], v[64:79]
ds_read_b128 v[40:43], v0 offset:33280
s_waitcnt lgkmcnt(3)
v_mfma_f32_32x32x16_bf16 v[112:127], v[52:55], v[200:203], v[112:127]
v_mfma_f32_32x32x16_bf16 v[96:111], v[52:55], v[136:139], v[96:111]
ds_read_b128 v[44:47], v0 offset:49664
s_waitcnt lgkmcnt(3)
v_mfma_f32_32x32x16_bf16 v[80:95], v[32:35], v[204:207], v[80:95]
v_mfma_f32_32x32x16_bf16 v[64:79], v[32:35], v[140:143], v[64:79]
ds_read_b128 v[48:51], v1 offset:33280
s_waitcnt lgkmcnt(3)
v_mfma_f32_32x32x16_bf16 v[112:127], v[36:39], v[204:207], v[112:127]
v_mfma_f32_32x32x16_bf16 v[96:111], v[36:39], v[140:143], v[96:111]
ds_read_b128 v[52:55], v1 offset:49664
s_waitcnt lgkmcnt(3)
v_mfma_f32_32x32x16_bf16 v[80:95], v[40:43], v[208:211], v[80:95]
v_mfma_f32_32x32x16_bf16 v[64:79], v[40:43], v[144:147], v[64:79]
ds_read_b128 v[32:35], v0 offset:33536
s_waitcnt lgkmcnt(3)
v_mfma_f32_32x32x16_bf16 v[112:127], v[44:47], v[208:211], v[112:127]
v_mfma_f32_32x32x16_bf16 v[96:111], v[44:47], v[144:147], v[96:111]
ds_read_b128 v[36:39], v0 offset:49920
s_waitcnt lgkmcnt(3)
v_mfma_f32_32x32x16_bf16 v[80:95], v[48:51], v[212:215], v[80:95]
v_mfma_f32_32x32x16_bf16 v[64:79], v[48:51], v[148:151], v[64:79]
ds_read_b128 v[40:43], v1 offset:33536
s_waitcnt lgkmcnt(3)
v_mfma_f32_32x32x16_bf16 v[112:127], v[52:55], v[212:215], v[112:127]
v_mfma_f32_32x32x16_bf16 v[96:111], v[52:55], v[148:151], v[96:111]
ds_read_b128 v[44:47], v1 offset:49920
s_waitcnt lgkmcnt(3)
v_mfma_f32_32x32x16_bf16 v[80:95], v[32:35], v[216:219], v[80:95]
s_barrier
v_mfma_f32_32x32x16_bf16 v[64:79], v[32:35], v[152:155], v[64:79]
ds_read_b128 v[48:51], v0 offset:33792
ds_write_b128 v2, v[16:19] offset:0
s_waitcnt lgkmcnt(4)
v_mfma_f32_32x32x16_bf16 v[112:127], v[36:39], v[216:219], v[112:127]
ds_write_b128 v15, v[20:23] offset:0
v_mfma_f32_32x32x16_bf16 v[96:111], v[36:39], v[152:155], v[96:111]
ds_read_b128 v[52:55], v0 offset:50176
ds_write_b128 v2, v[24:27] offset:16384
s_waitcnt lgkmcnt(6)
v_mfma_f32_32x32x16_bf16 v[80:95], v[40:43], v[220:223], v[80:95]
ds_write_b128 v15, v[28:31] offset:16384
v_mfma_f32_32x32x16_bf16 v[64:79], v[40:43], v[156:159], v[64:79]
ds_read_b128 v[32:35], v1 offset:33792
s_waitcnt lgkmcnt(7)
v_mfma_f32_32x32x16_bf16 v[112:127], v[44:47], v[220:223], v[112:127]
s_add_u32 m0, s36, 0
s_xor_b32 s37, s31, 0
buffer_load_dwordx4 v9, s[16:19], s37 offen lds
v_mfma_f32_32x32x16_bf16 v[96:111], v[44:47], v[156:159], v[96:111]
ds_read_b128 v[36:39], v1 offset:50176
s_waitcnt lgkmcnt(7)
v_mfma_f32_32x32x16_bf16 v[80:95], v[48:51], v[224:227], v[80:95]
s_add_u32 m0, s36, 1024
s_xor_b32 s37, s31, 4096
buffer_load_dwordx4 v9, s[16:19], s37 offen lds
v_mfma_f32_32x32x16_bf16 v[64:79], v[48:51], v[160:163], v[64:79]
ds_read_b128 v[40:43], v0 offset:34048
s_waitcnt lgkmcnt(5)
v_mfma_f32_32x32x16_bf16 v[112:127], v[52:55], v[224:227], v[112:127]
s_add_u32 m0, s36, 2048
s_xor_b32 s37, s31, 8192
buffer_load_dwordx4 v9, s[16:19], s37 offen lds
v_mfma_f32_32x32x16_bf16 v[96:111], v[52:55], v[160:163], v[96:111]
ds_read_b128 v[44:47], v0 offset:50432
s_waitcnt lgkmcnt(3)
v_mfma_f32_32x32x16_bf16 v[80:95], v[32:35], v[228:231], v[80:95]
s_add_u32 m0, s36, 3072
s_xor_b32 s37, s31, 12288
buffer_load_dwordx4 v9, s[16:19], s37 offen lds
v_mfma_f32_32x32x16_bf16 v[64:79], v[32:35], v[164:167], v[64:79]
ds_read_b128 v[48:51], v1 offset:34048
s_waitcnt lgkmcnt(3)
v_mfma_f32_32x32x16_bf16 v[112:127], v[36:39], v[228:231], v[112:127]
s_add_u32 m0, s36, 4096
s_xor_b32 s37, s31, 16384
buffer_load_dwordx4 v9, s[16:19], s37 offen lds
v_mfma_f32_32x32x16_bf16 v[96:111], v[36:39], v[164:167], v[96:111]
ds_read_b128 v[52:55], v1 offset:50432
s_waitcnt lgkmcnt(3)
v_mfma_f32_32x32x16_bf16 v[80:95], v[40:43], v[232:235], v[80:95]
s_add_u32 m0, s36, 5120
s_xor_b32 s37, s31, 20480
buffer_load_dwordx4 v9, s[16:19], s37 offen lds
v_mfma_f32_32x32x16_bf16 v[64:79], v[40:43], v[168:171], v[64:79]
ds_read_b128 v[32:35], v0 offset:34304
s_waitcnt lgkmcnt(3)
v_mfma_f32_32x32x16_bf16 v[112:127], v[44:47], v[232:235], v[112:127]
s_add_u32 m0, s36, 6144
s_xor_b32 s37, s31, 24576
buffer_load_dwordx4 v9, s[16:19], s37 offen lds
v_mfma_f32_32x32x16_bf16 v[96:111], v[44:47], v[168:171], v[96:111]
ds_read_b128 v[36:39], v0 offset:50688
s_waitcnt lgkmcnt(3)
v_mfma_f32_32x32x16_bf16 v[80:95], v[48:51], v[236:239], v[80:95]
s_add_u32 m0, s36, 7168
s_xor_b32 s37, s31, 28672
buffer_load_dwordx4 v9, s[16:19], s37 offen lds
v_mfma_f32_32x32x16_bf16 v[64:79], v[48:51], v[172:175], v[64:79]
ds_read_b128 v[40:43], v1 offset:34304
s_waitcnt lgkmcnt(3)
v_mfma_f32_32x32x16_bf16 v[112:127], v[52:55], v[236:239], v[112:127]
s_add_u32 m0, s36, 8192
s_xor_b32 s37, s31, 32768
buffer_load_dwordx4 v9, s[16:19], s37 offen lds
v_mfma_f32_32x32x16_bf16 v[96:111], v[52:55], v[172:175], v[96:111]
ds_read_b128 v[44:47], v1 offset:50688
s_waitcnt lgkmcnt(3)
v_mfma_f32_32x32x16_bf16 v[80:95], v[32:35], v[240:243], v[80:95]
s_add_u32 m0, s36, 9216
s_xor_b32 s37, s31, 36864
buffer_load_dwordx4 v9, s[16:19], s37 offen lds
v_mfma_f32_32x32x16_bf16 v[64:79], v[32:35], v[176:179], v[64:79]
ds_read_b128 v[48:51], v0 offset:34560
s_waitcnt lgkmcnt(3)
v_mfma_f32_32x32x16_bf16 v[112:127], v[36:39], v[240:243], v[112:127]
s_add_u32 m0, s36, 10240
s_xor_b32 s37, s31, 40960
buffer_load_dwordx4 v9, s[16:19], s37 offen lds
v_mfma_f32_32x32x16_bf16 v[96:111], v[36:39], v[176:179], v[96:111]
ds_read_b128 v[52:55], v0 offset:50944
s_waitcnt vmcnt(10)
ds_read_b64_tr_b16 v[128:129], v10 offset:0
ds_read_b64_tr_b16 v[192:193], v10 offset:512
s_waitcnt lgkmcnt(5)
v_mfma_f32_32x32x16_bf16 v[80:95], v[40:43], v[244:247], v[80:95]
s_add_u32 m0, s36, 11264
s_xor_b32 s37, s31, 45056
buffer_load_dwordx4 v9, s[16:19], s37 offen lds
v_mfma_f32_32x32x16_bf16 v[64:79], v[40:43], v[180:183], v[64:79]
ds_read_b128 v[32:35], v1 offset:34560
s_waitcnt vmcnt(10)
ds_read_b64_tr_b16 v[130:131], v10 offset:1024
ds_read_b64_tr_b16 v[194:195], v10 offset:1536
s_waitcnt lgkmcnt(7)
v_mfma_f32_32x32x16_bf16 v[112:127], v[44:47], v[244:247], v[112:127]
s_add_u32 m0, s36, 12288
s_xor_b32 s37, s31, 49152
buffer_load_dwordx4 v9, s[16:19], s37 offen lds
v_mfma_f32_32x32x16_bf16 v[96:111], v[44:47], v[180:183], v[96:111]
ds_read_b128 v[36:39], v1 offset:50944
s_waitcnt vmcnt(10)
ds_read_b64_tr_b16 v[132:133], v10 offset:2048
ds_read_b64_tr_b16 v[196:197], v10 offset:2560
s_waitcnt lgkmcnt(9)
v_mfma_f32_32x32x16_bf16 v[80:95], v[48:51], v[248:251], v[80:95]
s_add_u32 m0, s36, 13312
s_xor_b32 s37, s31, 53248
buffer_load_dwordx4 v9, s[16:19], s37 offen lds
v_mfma_f32_32x32x16_bf16 v[64:79], v[48:51], v[184:187], v[64:79]
s_waitcnt vmcnt(10)
ds_read_b64_tr_b16 v[134:135], v10 offset:3072
ds_read_b64_tr_b16 v[198:199], v10 offset:3584
s_waitcnt lgkmcnt(10)
v_mfma_f32_32x32x16_bf16 v[112:127], v[52:55], v[248:251], v[112:127]
s_add_u32 m0, s36, 14336
s_xor_b32 s37, s31, 57344
buffer_load_dwordx4 v9, s[16:19], s37 offen lds
v_mfma_f32_32x32x16_bf16 v[96:111], v[52:55], v[184:187], v[96:111]
s_waitcnt vmcnt(10)
ds_read_b64_tr_b16 v[136:137], v10 offset:4096
ds_read_b64_tr_b16 v[200:201], v10 offset:4608
s_waitcnt lgkmcnt(9)
v_mfma_f32_32x32x16_bf16 v[80:95], v[32:35], v[252:255], v[80:95]
s_add_u32 m0, s36, 15360
s_xor_b32 s37, s31, 61440
buffer_load_dwordx4 v9, s[16:19], s37 offen lds
v_mfma_f32_32x32x16_bf16 v[64:79], v[32:35], v[188:191], v[64:79]
s_waitcnt vmcnt(10)
ds_read_b64_tr_b16 v[138:139], v10 offset:5120
ds_read_b64_tr_b16 v[202:203], v10 offset:5632
s_waitcnt lgkmcnt(8)
v_mfma_f32_32x32x16_bf16 v[112:127], v[36:39], v[252:255], v[112:127]
v_mfma_f32_32x32x16_bf16 v[96:111], v[36:39], v[188:191], v[96:111]
s_waitcnt vmcnt(9)
ds_read_b64_tr_b16 v[140:141], v10 offset:6144
ds_read_b64_tr_b16 v[204:205], v10 offset:6656
s_setprio 0
v_mul_f32 v80, v8, v80
v_mul_f32 v81, v8, v81
v_exp_f32 v80, v80
v_exp_f32 v81, v81
v_mul_f32 v82, v8, v82
v_mul_f32 v83, v8, v83
v_add_f32 v80, 1.0, v80
v_add_f32 v81, 1.0, v81
v_exp_f32 v82, v82
v_exp_f32 v83, v83
v_rcp_f32 v80, v80
v_rcp_f32 v81, v81
v_mul_f32 v84, v8, v84
v_mul_f32 v85, v8, v85
v_mul_f32 v64, v64, v80
v_mul_f32 v65, v65, v81
v_add_f32 v82, 1.0, v82
v_add_f32 v83, 1.0, v83
v_mul_f32 v80, v7, v64
v_mul_f32 v81, v7, v65
v_fmac_f32 v80, v6, v4
v_fmac_f32 v81, v6, v64
v_fmac_f32 v80, v5, v3
v_fmac_f32 v81, v5, v4
v_exp_f32 v84, v84
v_exp_f32 v85, v85
v_rcp_f32 v82, v82
v_rcp_f32 v83, v83
v_exp_f32 v3, v80
v_exp_f32 v4, v81
v_mul_f32 v86, v8, v86
v_mul_f32 v87, v8, v87
v_mul_f32 v66, v66, v82
v_mul_f32 v67, v67, v83
v_add_f32 v84, 1.0, v84
v_add_f32 v85, 1.0, v85
v_mul_f32 v82, v7, v66
v_mul_f32 v83, v7, v67
v_fmac_f32 v82, v6, v65
v_fmac_f32 v83, v6, v66
v_fmac_f32 v82, v5, v64
v_fmac_f32 v83, v5, v65
v_fmaak_f32 v3, v8, v3, 0xbfb8aa3b
v_fmaak_f32 v4, v8, v4, 0xbfb8aa3b
v_exp_f32 v86, v86
v_exp_f32 v87, v87
v_rcp_f32 v84, v84
v_rcp_f32 v85, v85
v_exp_f32 v64, v82
v_exp_f32 v65, v83
v_rcp_f32 v3, v3
v_rcp_f32 v4, v4
v_mul_f32 v88, v8, v88
v_mul_f32 v89, v8, v89
v_mul_f32 v68, v68, v84
v_mul_f32 v69, v69, v85
v_add_f32 v86, 1.0, v86
v_add_f32 v87, 1.0, v87
v_mul_f32 v84, v7, v68
v_mul_f32 v85, v7, v69
v_fmac_f32 v84, v6, v67
v_fmac_f32 v85, v6, v68
v_fmac_f32 v84, v5, v66
v_fmac_f32 v85, v5, v67
v_fmaak_f32 v64, v8, v64, 0xbfb8aa3b
v_fmaak_f32 v65, v8, v65, 0xbfb8aa3b
v_mul_f32 v80, v80, v3
v_mul_f32 v81, v81, v4
v_xor_b32 v0, 16, v12
v_xor_b32 v1, 64, v12
v_xor_b32 v9, 80, v12
s_waitcnt vmcnt(8)
ds_read_b64_tr_b16 v[142:143], v10 offset:7168
ds_read_b64_tr_b16 v[206:207], v10 offset:7680
s_waitcnt vmcnt(7)
ds_read_b64_tr_b16 v[144:145], v10 offset:8192
ds_read_b64_tr_b16 v[208:209], v10 offset:8704
s_waitcnt vmcnt(6)
ds_read_b64_tr_b16 v[146:147], v10 offset:9216
ds_read_b64_tr_b16 v[210:211], v10 offset:9728
s_waitcnt vmcnt(5)
ds_read_b64_tr_b16 v[148:149], v10 offset:10240
ds_read_b64_tr_b16 v[212:213], v10 offset:10752
s_waitcnt vmcnt(4)
ds_read_b64_tr_b16 v[150:151], v10 offset:11264
ds_read_b64_tr_b16 v[214:215], v10 offset:11776
s_waitcnt vmcnt(3)
ds_read_b64_tr_b16 v[152:153], v10 offset:12288
ds_read_b64_tr_b16 v[216:217], v10 offset:12800
s_waitcnt vmcnt(2)
ds_read_b64_tr_b16 v[154:155], v10 offset:13312
ds_read_b64_tr_b16 v[218:219], v10 offset:13824
s_waitcnt vmcnt(1)
ds_read_b64_tr_b16 v[156:157], v10 offset:14336
ds_read_b64_tr_b16 v[220:221], v10 offset:14848
s_waitcnt vmcnt(0)
ds_read_b64_tr_b16 v[158:159], v10 offset:15360
ds_read_b64_tr_b16 v[222:223], v10 offset:15872
v_exp_f32 v88, v88
v_exp_f32 v89, v89
v_rcp_f32 v86, v86
v_rcp_f32 v87, v87
v_exp_f32 v66, v84
v_exp_f32 v67, v85
v_rcp_f32 v64, v64
v_rcp_f32 v65, v65
v_cvt_pk_bf16_f32 v80, v80, v81
s_waitcnt lgkmcnt(0)
s_barrier
v_mul_f32 v90, v8, v90
v_mul_f32 v91, v8, v91
v_mul_f32 v70, v70, v86
v_mul_f32 v71, v71, v87
v_add_f32 v88, 1.0, v88
v_add_f32 v89, 1.0, v89
v_mul_f32 v86, v7, v70
v_mul_f32 v87, v7, v71
v_fmac_f32 v86, v6, v69
v_fmac_f32 v87, v6, v70
v_fmac_f32 v86, v5, v68
v_fmac_f32 v87, v5, v69
v_fmaak_f32 v66, v8, v66, 0xbfb8aa3b
v_fmaak_f32 v67, v8, v67, 0xbfb8aa3b
v_mul_f32 v82, v82, v64
v_mul_f32 v83, v83, v65
v_exp_f32 v90, v90
v_exp_f32 v91, v91
v_rcp_f32 v88, v88
v_rcp_f32 v89, v89
v_exp_f32 v68, v86
v_exp_f32 v69, v87
v_rcp_f32 v66, v66
v_rcp_f32 v67, v67
v_cvt_pk_bf16_f32 v81, v82, v83
v_mul_f32 v92, v8, v92
v_mul_f32 v93, v8, v93
v_mul_f32 v72, v72, v88
v_mul_f32 v73, v73, v89
v_add_f32 v90, 1.0, v90
v_add_f32 v91, 1.0, v91
v_mul_f32 v88, v7, v72
v_mul_f32 v89, v7, v73
v_fmac_f32 v88, v6, v71
v_fmac_f32 v89, v6, v72
v_fmac_f32 v88, v5, v70
v_fmac_f32 v89, v5, v71
v_fmaak_f32 v68, v8, v68, 0xbfb8aa3b
v_fmaak_f32 v69, v8, v69, 0xbfb8aa3b
v_mul_f32 v84, v84, v66
v_mul_f32 v85, v85, v67
v_exp_f32 v92, v92
v_exp_f32 v93, v93
v_rcp_f32 v90, v90
v_rcp_f32 v91, v91
v_exp_f32 v70, v88
v_exp_f32 v71, v89
v_rcp_f32 v68, v68
v_rcp_f32 v69, v69
v_cvt_pk_bf16_f32 v82, v84, v85
v_mul_f32 v94, v8, v94
v_mul_f32 v95, v8, v95
v_mul_f32 v74, v74, v90
v_mul_f32 v75, v75, v91
v_add_f32 v92, 1.0, v92
v_add_f32 v93, 1.0, v93
v_mul_f32 v90, v7, v74
v_mul_f32 v91, v7, v75
v_fmac_f32 v90, v6, v73
v_fmac_f32 v91, v6, v74
v_fmac_f32 v90, v5, v72
v_fmac_f32 v91, v5, v73
v_fmaak_f32 v70, v8, v70, 0xbfb8aa3b
v_fmaak_f32 v71, v8, v71, 0xbfb8aa3b
v_mul_f32 v86, v86, v68
v_mul_f32 v87, v87, v69
v_exp_f32 v94, v94
v_exp_f32 v95, v95
v_rcp_f32 v92, v92
v_rcp_f32 v93, v93
v_exp_f32 v72, v90
v_exp_f32 v73, v91
v_rcp_f32 v70, v70
v_rcp_f32 v71, v71
v_cvt_pk_bf16_f32 v83, v86, v87
v_mul_f32 v112, v8, v112
v_mul_f32 v113, v8, v113
v_mul_f32 v76, v76, v92
v_mul_f32 v77, v77, v93
v_add_f32 v94, 1.0, v94
v_add_f32 v95, 1.0, v95
v_mul_f32 v92, v7, v76
v_mul_f32 v93, v7, v77
v_fmac_f32 v92, v6, v75
v_fmac_f32 v93, v6, v76
v_fmac_f32 v92, v5, v74
v_fmac_f32 v93, v5, v75
v_fmaak_f32 v72, v8, v72, 0xbfb8aa3b
v_fmaak_f32 v73, v8, v73, 0xbfb8aa3b
v_mul_f32 v88, v88, v70
v_mul_f32 v89, v89, v71
v_exp_f32 v112, v112
v_exp_f32 v113, v113
v_rcp_f32 v94, v94
v_rcp_f32 v95, v95
v_exp_f32 v74, v92
v_exp_f32 v75, v93
v_rcp_f32 v72, v72
v_rcp_f32 v73, v73
v_cvt_pk_bf16_f32 v84, v88, v89
v_mul_f32 v114, v8, v114
v_mul_f32 v115, v8, v115
v_mul_f32 v78, v78, v94
v_mul_f32 v79, v79, v95
v_add_f32 v112, 1.0, v112
v_add_f32 v113, 1.0, v113
v_mul_f32 v94, v7, v78
v_mul_f32 v95, v7, v79
v_fmac_f32 v94, v6, v77
v_fmac_f32 v95, v6, v78
v_fmac_f32 v94, v5, v76
v_fmac_f32 v95, v5, v77
v_fmaak_f32 v74, v8, v74, 0xbfb8aa3b
v_fmaak_f32 v75, v8, v75, 0xbfb8aa3b
v_mul_f32 v90, v90, v72
v_mul_f32 v91, v91, v73
v_exp_f32 v114, v114
v_exp_f32 v115, v115
v_rcp_f32 v112, v112
v_rcp_f32 v113, v113
v_exp_f32 v76, v94
v_exp_f32 v77, v95
v_rcp_f32 v74, v74
v_rcp_f32 v75, v75
v_cvt_pk_bf16_f32 v85, v90, v91
s_setprio 1
v_mul_f32 v116, v8, v116
v_mul_f32 v117, v8, v117
v_mul_f32 v96, v96, v112
v_mul_f32 v97, v97, v113
v_add_f32 v114, 1.0, v114
v_add_f32 v115, 1.0, v115
v_mul_f32 v112, v7, v96
v_mul_f32 v113, v7, v97
v_fmac_f32 v112, v6, v79
v_fmac_f32 v113, v6, v96
v_fmac_f32 v112, v5, v78
v_fmac_f32 v113, v5, v79
v_fmaak_f32 v76, v8, v76, 0xbfb8aa3b
v_fmaak_f32 v77, v8, v77, 0xbfb8aa3b
v_mul_f32 v92, v92, v74
v_mul_f32 v93, v93, v75
v_exp_f32 v116, v116
v_exp_f32 v117, v117
v_rcp_f32 v114, v114
v_rcp_f32 v115, v115
v_exp_f32 v78, v112
v_exp_f32 v79, v113
v_rcp_f32 v76, v76
v_rcp_f32 v77, v77
v_cvt_pk_bf16_f32 v86, v92, v93
v_mul_f32 v118, v8, v118
v_mul_f32 v119, v8, v119
v_mul_f32 v98, v98, v114
v_mul_f32 v99, v99, v115
v_add_f32 v116, 1.0, v116
v_add_f32 v117, 1.0, v117
v_mul_f32 v114, v7, v98
v_mul_f32 v115, v7, v99
v_fmac_f32 v114, v6, v97
v_fmac_f32 v115, v6, v98
v_fmac_f32 v114, v5, v96
v_fmac_f32 v115, v5, v97
v_fmaak_f32 v78, v8, v78, 0xbfb8aa3b
v_fmaak_f32 v79, v8, v79, 0xbfb8aa3b
v_mul_f32 v94, v94, v76
v_mul_f32 v95, v95, v77
v_exp_f32 v118, v118
v_exp_f32 v119, v119
v_rcp_f32 v116, v116
v_rcp_f32 v117, v117
v_exp_f32 v96, v114
v_exp_f32 v97, v115
v_rcp_f32 v78, v78
v_rcp_f32 v79, v79
v_cvt_pk_bf16_f32 v87, v94, v95
ds_write_b128 v2, v[80:83] offset:32768
ds_write_b128 v15, v[84:87] offset:32768
v_mul_f32 v120, v8, v120
v_mul_f32 v121, v8, v121
v_mul_f32 v100, v100, v116
v_mul_f32 v101, v101, v117
v_add_f32 v118, 1.0, v118
v_add_f32 v119, 1.0, v119
v_mul_f32 v116, v7, v100
v_mul_f32 v117, v7, v101
v_fmac_f32 v116, v6, v99
v_fmac_f32 v117, v6, v100
v_fmac_f32 v116, v5, v98
v_fmac_f32 v117, v5, v99
v_fmaak_f32 v96, v8, v96, 0xbfb8aa3b
v_fmaak_f32 v97, v8, v97, 0xbfb8aa3b
v_mul_f32 v112, v112, v78
v_mul_f32 v113, v113, v79
ds_read_b64_tr_b16 v[16:17], v11 offset:0
ds_read_b64_tr_b16 v[18:19], v11 offset:512
ds_read_b64_tr_b16 v[20:21], v11 offset:1024
ds_read_b64_tr_b16 v[22:23], v11 offset:1536
ds_read_b64_tr_b16 v[24:25], v11 offset:2048
ds_read_b64_tr_b16 v[26:27], v11 offset:2560
v_exp_f32 v120, v120
v_exp_f32 v121, v121
v_rcp_f32 v118, v118
v_rcp_f32 v119, v119
v_exp_f32 v98, v116
v_exp_f32 v99, v117
v_rcp_f32 v96, v96
v_rcp_f32 v97, v97
v_cvt_pk_bf16_f32 v112, v112, v113
s_waitcnt lgkmcnt(6)
s_barrier
v_mul_f32 v122, v8, v122
v_mul_f32 v123, v8, v123
v_mul_f32 v102, v102, v118
v_mul_f32 v103, v103, v119
v_add_f32 v120, 1.0, v120
v_add_f32 v121, 1.0, v121
s_waitcnt lgkmcnt(4)
v_mfma_f32_32x32x16_bf16 v[32:47], v[128:131], v[16:19], 0
ds_read_b64_tr_b16 v[28:29], v11 offset:3072
v_mul_f32 v118, v7, v102
v_mul_f32 v119, v7, v103
v_fmac_f32 v118, v6, v101
v_fmac_f32 v119, v6, v102
v_fmac_f32 v118, v5, v100
v_fmac_f32 v119, v5, v101
v_mfma_f32_32x32x16_bf16 v[48:63], v[192:195], v[16:19], 0
ds_read_b64_tr_b16 v[30:31], v11 offset:3584
v_fmaak_f32 v98, v8, v98, 0xbfb8aa3b
v_fmaak_f32 v99, v8, v99, 0xbfb8aa3b
v_mul_f32 v114, v114, v96
v_mul_f32 v115, v115, v97
v_exp_f32 v122, v122
s_waitcnt lgkmcnt(4)
v_mfma_f32_32x32x16_bf16 v[32:47], v[132:135], v[20:23], v[32:47]
ds_read_b64_tr_b16 v[16:17], v11 offset:4096
v_exp_f32 v123, v123
v_rcp_f32 v120, v120
v_rcp_f32 v121, v121
v_mfma_f32_32x32x16_bf16 v[48:63], v[196:199], v[20:23], v[48:63]
ds_read_b64_tr_b16 v[18:19], v11 offset:4608
v_exp_f32 v100, v118
v_exp_f32 v101, v119
v_rcp_f32 v98, v98
s_waitcnt lgkmcnt(4)
v_mfma_f32_32x32x16_bf16 v[32:47], v[136:139], v[24:27], v[32:47]
ds_read_b64_tr_b16 v[20:21], v11 offset:5120
v_rcp_f32 v99, v99
v_cvt_pk_bf16_f32 v113, v114, v115
v_mul_f32 v124, v8, v124
v_mul_f32 v125, v8, v125
v_mul_f32 v104, v104, v120
v_mfma_f32_32x32x16_bf16 v[48:63], v[200:203], v[24:27], v[48:63]
ds_read_b64_tr_b16 v[22:23], v11 offset:5632
v_mul_f32 v105, v105, v121
v_add_f32 v122, 1.0, v122
v_add_f32 v123, 1.0, v123
v_mul_f32 v120, v7, v104
v_mul_f32 v121, v7, v105
v_fmac_f32 v120, v6, v103
s_waitcnt lgkmcnt(4)
v_mfma_f32_32x32x16_bf16 v[32:47], v[140:143], v[28:31], v[32:47]
ds_read_b64_tr_b16 v[24:25], v11 offset:6144
v_fmac_f32 v121, v6, v104
v_fmac_f32 v120, v5, v102
v_fmac_f32 v121, v5, v103
v_fmaak_f32 v100, v8, v100, 0xbfb8aa3b
v_fmaak_f32 v101, v8, v101, 0xbfb8aa3b
v_mul_f32 v116, v116, v98
v_mfma_f32_32x32x16_bf16 v[48:63], v[204:207], v[28:31], v[48:63]
ds_read_b64_tr_b16 v[26:27], v11 offset:6656
v_mul_f32 v117, v117, v99
v_exp_f32 v124, v124
v_exp_f32 v125, v125
v_rcp_f32 v122, v122
s_waitcnt lgkmcnt(4)
v_mfma_f32_32x32x16_bf16 v[32:47], v[144:147], v[16:19], v[32:47]
ds_read_b64_tr_b16 v[28:29], v11 offset:7168
v_rcp_f32 v123, v123
v_exp_f32 v102, v120
v_exp_f32 v103, v121
v_mfma_f32_32x32x16_bf16 v[48:63], v[208:211], v[16:19], v[48:63]
ds_read_b64_tr_b16 v[30:31], v11 offset:7680
v_rcp_f32 v100, v100
v_rcp_f32 v101, v101
v_cvt_pk_bf16_f32 v114, v116, v117
v_mul_f32 v126, v8, v126
s_waitcnt lgkmcnt(4)
v_mfma_f32_32x32x16_bf16 v[32:47], v[148:151], v[20:23], v[32:47]
ds_read_b64_tr_b16 v[160:161], v10 offset:0
ds_read_b64_tr_b16 v[224:225], v10 offset:512
ds_read_b64_tr_b16 v[16:17], v11 offset:8192
v_mul_f32 v127, v8, v127
v_mul_f32 v106, v106, v122
v_mul_f32 v107, v107, v123
v_add_f32 v124, 1.0, v124
v_add_f32 v125, 1.0, v125
v_mul_f32 v122, v7, v106
v_mfma_f32_32x32x16_bf16 v[48:63], v[212:215], v[20:23], v[48:63]
ds_read_b64_tr_b16 v[162:163], v10 offset:1024
ds_read_b64_tr_b16 v[226:227], v10 offset:1536
ds_read_b64_tr_b16 v[18:19], v11 offset:8704
v_mul_f32 v123, v7, v107
v_fmac_f32 v122, v6, v105
v_fmac_f32 v123, v6, v106
v_fmac_f32 v122, v5, v104
v_fmac_f32 v123, v5, v105
v_fmaak_f32 v102, v8, v102, 0xbfb8aa3b
s_waitcnt lgkmcnt(8)
v_mfma_f32_32x32x16_bf16 v[32:47], v[152:155], v[24:27], v[32:47]
ds_read_b64_tr_b16 v[164:165], v10 offset:2048
ds_read_b64_tr_b16 v[228:229], v10 offset:2560
ds_read_b64_tr_b16 v[20:21], v11 offset:9216
v_fmaak_f32 v103, v8, v103, 0xbfb8aa3b
v_mul_f32 v118, v118, v100
v_mul_f32 v119, v119, v101
v_exp_f32 v126, v126
v_exp_f32 v127, v127
v_mfma_f32_32x32x16_bf16 v[48:63], v[216:219], v[24:27], v[48:63]
ds_read_b64_tr_b16 v[166:167], v10 offset:3072
ds_read_b64_tr_b16 v[230:231], v10 offset:3584
ds_read_b64_tr_b16 v[22:23], v11 offset:9728
v_rcp_f32 v124, v124
v_rcp_f32 v125, v125
v_exp_f32 v104, v122
s_waitcnt lgkmcnt(12)
v_mfma_f32_32x32x16_bf16 v[32:47], v[156:159], v[28:31], v[32:47]
ds_read_b64_tr_b16 v[168:169], v10 offset:4096
ds_read_b64_tr_b16 v[232:233], v10 offset:4608
ds_read_b64_tr_b16 v[24:25], v11 offset:10240
v_exp_f32 v105, v123
v_rcp_f32 v102, v102
v_rcp_f32 v103, v103
v_mfma_f32_32x32x16_bf16 v[48:63], v[220:223], v[28:31], v[48:63]
ds_read_b64_tr_b16 v[170:171], v10 offset:5120
ds_read_b64_tr_b16 v[234:235], v10 offset:5632
ds_read_b64_tr_b16 v[26:27], v11 offset:10752
v_cvt_pk_bf16_f32 v115, v118, v119
v_mul_f32 v108, v108, v124
v_mul_f32 v109, v109, v125
v_add_f32 v126, 1.0, v126
v_add_f32 v127, 1.0, v127
v_mul_f32 v124, v7, v108
s_waitcnt lgkmcnt(12)
v_mfma_f32_32x32x16_bf16 v[32:47], v[160:163], v[16:19], v[32:47]
ds_read_b64_tr_b16 v[172:173], v10 offset:6144
ds_read_b64_tr_b16 v[236:237], v10 offset:6656
ds_read_b64_tr_b16 v[28:29], v11 offset:11264
v_mul_f32 v125, v7, v109
v_fmac_f32 v124, v6, v107
v_fmac_f32 v125, v6, v108
v_fmac_f32 v124, v5, v106
v_fmac_f32 v125, v5, v107
v_fmaak_f32 v104, v8, v104, 0xbfb8aa3b
v_mfma_f32_32x32x16_bf16 v[48:63], v[224:227], v[16:19], v[48:63]
ds_read_b64_tr_b16 v[174:175], v10 offset:7168
ds_read_b64_tr_b16 v[238:239], v10 offset:7680
ds_read_b64_tr_b16 v[30:31], v11 offset:11776
v_fmaak_f32 v105, v8, v105, 0xbfb8aa3b
v_mul_f32 v120, v120, v102
v_mul_f32 v121, v121, v103
v_rcp_f32 v126, v126
v_rcp_f32 v127, v127
s_waitcnt lgkmcnt(12)
v_mfma_f32_32x32x16_bf16 v[32:47], v[164:167], v[20:23], v[32:47]
ds_read_b64_tr_b16 v[176:177], v10 offset:8192
ds_read_b64_tr_b16 v[240:241], v10 offset:8704
ds_read_b64_tr_b16 v[16:17], v11 offset:12288
v_exp_f32 v106, v124
v_exp_f32 v107, v125
v_rcp_f32 v104, v104
v_mfma_f32_32x32x16_bf16 v[48:63], v[228:231], v[20:23], v[48:63]
ds_read_b64_tr_b16 v[178:179], v10 offset:9216
ds_read_b64_tr_b16 v[242:243], v10 offset:9728
ds_read_b64_tr_b16 v[18:19], v11 offset:12800
v_rcp_f32 v105, v105
v_cvt_pk_bf16_f32 v116, v120, v121
v_mul_f32 v3, v110, v126
v_mul_f32 v4, v111, v127
v_mul_f32 v126, v7, v3
s_waitcnt lgkmcnt(12)
v_mfma_f32_32x32x16_bf16 v[32:47], v[168:171], v[24:27], v[32:47]
ds_read_b64_tr_b16 v[180:181], v10 offset:10240
ds_read_b64_tr_b16 v[244:245], v10 offset:10752
ds_read_b64_tr_b16 v[20:21], v11 offset:13312
v_mul_f32 v127, v7, v4
v_fmac_f32 v126, v6, v109
v_fmac_f32 v127, v6, v3
v_fmac_f32 v126, v5, v108
v_fmac_f32 v127, v5, v109
v_fmaak_f32 v106, v8, v106, 0xbfb8aa3b
v_mfma_f32_32x32x16_bf16 v[48:63], v[232:235], v[24:27], v[48:63]
ds_read_b64_tr_b16 v[182:183], v10 offset:11264
ds_read_b64_tr_b16 v[246:247], v10 offset:11776
ds_read_b64_tr_b16 v[22:23], v11 offset:13824
v_fmaak_f32 v107, v8, v107, 0xbfb8aa3b
v_mul_f32 v122, v122, v104
v_mul_f32 v123, v123, v105
v_exp_f32 v108, v126
v_exp_f32 v109, v127
s_waitcnt lgkmcnt(12)
v_mfma_f32_32x32x16_bf16 v[32:47], v[172:175], v[28:31], v[32:47]
ds_read_b64_tr_b16 v[184:185], v10 offset:12288
ds_read_b64_tr_b16 v[248:249], v10 offset:12800
ds_read_b64_tr_b16 v[24:25], v11 offset:14336
v_rcp_f32 v106, v106
v_rcp_f32 v107, v107
v_cvt_pk_bf16_f32 v117, v122, v123
v_fmaak_f32 v108, v8, v108, 0xbfb8aa3b
v_mfma_f32_32x32x16_bf16 v[48:63], v[236:239], v[28:31], v[48:63]
ds_read_b64_tr_b16 v[186:187], v10 offset:13312
ds_read_b64_tr_b16 v[250:251], v10 offset:13824
ds_read_b64_tr_b16 v[26:27], v11 offset:14848
v_fmaak_f32 v109, v8, v109, 0xbfb8aa3b
v_mul_f32 v124, v124, v106
v_mul_f32 v125, v125, v107
v_rcp_f32 v108, v108
v_rcp_f32 v109, v109
v_cvt_pk_bf16_f32 v118, v124, v125
v_mul_f32 v126, v126, v108
v_mul_f32 v127, v127, v109
v_cvt_pk_bf16_f32 v119, v126, v127
s_setprio 3
s_waitcnt lgkmcnt(12)
v_mfma_f32_32x32x16_bf16 v[32:47], v[176:179], v[16:19], v[32:47]
ds_read_b64_tr_b16 v[188:189], v10 offset:14336
ds_read_b64_tr_b16 v[252:253], v10 offset:14848
ds_read_b64_tr_b16 v[28:29], v11 offset:15360
v_mfma_f32_32x32x16_bf16 v[48:63], v[240:243], v[16:19], v[48:63]
ds_read_b64_tr_b16 v[190:191], v10 offset:15360
ds_read_b64_tr_b16 v[254:255], v10 offset:15872
ds_read_b64_tr_b16 v[30:31], v11 offset:15872
s_waitcnt lgkmcnt(12)
v_mfma_f32_32x32x16_bf16 v[32:47], v[180:183], v[20:23], v[32:47]
ds_read_b64_tr_b16 v[16:17], v11 offset:16384
ds_write_b128 v2, v[112:115] offset:49152
v_mfma_f32_32x32x16_bf16 v[48:63], v[244:247], v[20:23], v[48:63]
ds_read_b64_tr_b16 v[18:19], v11 offset:16896
s_waitcnt lgkmcnt(9)
v_mfma_f32_32x32x16_bf16 v[32:47], v[184:187], v[24:27], v[32:47]
ds_read_b64_tr_b16 v[20:21], v11 offset:17408
ds_write_b128 v15, v[116:119] offset:49152
v_mfma_f32_32x32x16_bf16 v[48:63], v[248:251], v[24:27], v[48:63]
ds_read_b64_tr_b16 v[22:23], v11 offset:17920
s_waitcnt lgkmcnt(6)
v_mfma_f32_32x32x16_bf16 v[32:47], v[188:191], v[28:31], v[32:47]
s_nop 1
ds_read_b64_tr_b16 v[24:25], v11 offset:18432
v_mfma_f32_32x32x16_bf16 v[48:63], v[252:255], v[28:31], v[48:63]
s_nop 0
ds_read_b64_tr_b16 v[26:27], v11 offset:18944
s_waitcnt lgkmcnt(5)
v_mfma_f32_32x32x16_bf16 v[64:79], v[128:131], v[16:19], 0
s_nop 0
ds_read_b64_tr_b16 v[28:29], v11 offset:19456
v_mfma_f32_32x32x16_bf16 v[80:95], v[192:195], v[16:19], 0
ds_read_b64_tr_b16 v[30:31], v11 offset:19968
v_cvt_pk_bf16_f32 v32, v32, v33
v_cvt_pk_bf16_f32 v33, v34, v35
v_cvt_pk_bf16_f32 v34, v36, v37
v_cvt_pk_bf16_f32 v35, v38, v39
s_waitcnt lgkmcnt(4)
v_mfma_f32_32x32x16_bf16 v[64:79], v[132:135], v[20:23], v[64:79]
ds_read_b64_tr_b16 v[16:17], v11 offset:20480
ds_write_b128 v12, v[32:35]
v_mfma_f32_32x32x16_bf16 v[80:95], v[196:199], v[20:23], v[80:95]
ds_read_b64_tr_b16 v[18:19], v11 offset:20992
v_cvt_pk_bf16_f32 v36, v40, v41
v_cvt_pk_bf16_f32 v37, v42, v43
v_cvt_pk_bf16_f32 v38, v44, v45
v_cvt_pk_bf16_f32 v39, v46, v47
s_waitcnt lgkmcnt(5)
v_mfma_f32_32x32x16_bf16 v[64:79], v[136:139], v[24:27], v[64:79]
ds_read_b64_tr_b16 v[20:21], v11 offset:21504
ds_write_b128 v0, v[36:39]
v_mfma_f32_32x32x16_bf16 v[80:95], v[200:203], v[24:27], v[80:95]
ds_read_b64_tr_b16 v[22:23], v11 offset:22016
v_cvt_pk_bf16_f32 v48, v48, v49
v_cvt_pk_bf16_f32 v49, v50, v51
v_cvt_pk_bf16_f32 v50, v52, v53
v_cvt_pk_bf16_f32 v51, v54, v55
s_waitcnt lgkmcnt(6)
v_mfma_f32_32x32x16_bf16 v[64:79], v[140:143], v[28:31], v[64:79]
ds_read_b64_tr_b16 v[24:25], v11 offset:22528
ds_write_b128 v1, v[48:51]
v_mfma_f32_32x32x16_bf16 v[80:95], v[204:207], v[28:31], v[80:95]
ds_read_b64_tr_b16 v[26:27], v11 offset:23040
v_cvt_pk_bf16_f32 v52, v56, v57
v_cvt_pk_bf16_f32 v53, v58, v59
v_cvt_pk_bf16_f32 v54, v60, v61
v_cvt_pk_bf16_f32 v55, v62, v63
s_waitcnt lgkmcnt(6)
v_mfma_f32_32x32x16_bf16 v[64:79], v[144:147], v[16:19], v[64:79]
ds_read_b64_tr_b16 v[28:29], v11 offset:23552
ds_write_b128 v9, v[52:55]
v_mfma_f32_32x32x16_bf16 v[80:95], v[208:211], v[16:19], v[80:95]
ds_read_b64_tr_b16 v[30:31], v11 offset:24064
ds_read_b128 v[40:43], v13 offset:0
ds_read_b128 v[44:47], v13 offset:1024
s_waitcnt lgkmcnt(8)
v_mfma_f32_32x32x16_bf16 v[64:79], v[148:151], v[20:23], v[64:79]
ds_read_b64_tr_b16 v[16:17], v11 offset:24576
ds_read_b128 v[56:59], v13 offset:2048
ds_read_b128 v[60:63], v13 offset:3072
v_mfma_f32_32x32x16_bf16 v[80:95], v[212:215], v[20:23], v[80:95]
ds_read_b64_tr_b16 v[18:19], v11 offset:25088
s_waitcnt lgkmcnt(9)
v_mfma_f32_32x32x16_bf16 v[64:79], v[152:155], v[24:27], v[64:79]
ds_read_b64_tr_b16 v[20:21], v11 offset:25600
v_mfma_f32_32x32x16_bf16 v[80:95], v[216:219], v[24:27], v[80:95]
ds_read_b64_tr_b16 v[22:23], v11 offset:26112
s_movk_i32 s38, 24576
s_waitcnt lgkmcnt(7)
buffer_store_dwordx4 v[40:43], v14, s[20:23], s38 offen sc1 nt
v_mfma_f32_32x32x16_bf16 v[64:79], v[156:159], v[28:31], v[64:79]
ds_read_b64_tr_b16 v[24:25], v11 offset:26624
s_movk_i32 s38, 28672
s_mov_b32 exec_hi, 0x00ffffff
s_waitcnt lgkmcnt(7)
buffer_store_dwordx4 v[44:47], v14, s[20:23], s38 offen sc1 nt
s_mov_b64 exec, -1
v_mfma_f32_32x32x16_bf16 v[80:95], v[220:223], v[28:31], v[80:95]
ds_read_b64_tr_b16 v[26:27], v11 offset:27136
s_movk_i32 s38, 31744
s_mov_b32 exec_lo, 0xffffff00
s_waitcnt lgkmcnt(6)
buffer_store_dwordx4 v[56:59], v14, s[20:23], s38 offen sc1 nt
s_mov_b64 exec, -1
s_waitcnt lgkmcnt(4)
v_mfma_f32_32x32x16_bf16 v[64:79], v[160:163], v[16:19], v[64:79]
ds_read_b64_tr_b16 v[28:29], v11 offset:27648
s_mov_b32 s38, 35840
buffer_store_dwordx4 v[60:63], v14, s[20:23], s38 offen sc1 nt
v_mfma_f32_32x32x16_bf16 v[80:95], v[224:227], v[16:19], v[80:95]
ds_read_b64_tr_b16 v[30:31], v11 offset:28160
s_waitcnt lgkmcnt(4)
v_mfma_f32_32x32x16_bf16 v[64:79], v[164:167], v[20:23], v[64:79]
ds_read_b64_tr_b16 v[16:17], v11 offset:28672
v_mfma_f32_32x32x16_bf16 v[80:95], v[228:231], v[20:23], v[80:95]
ds_read_b64_tr_b16 v[18:19], v11 offset:29184
s_waitcnt lgkmcnt(4)
v_mfma_f32_32x32x16_bf16 v[64:79], v[168:171], v[24:27], v[64:79]
ds_read_b64_tr_b16 v[20:21], v11 offset:29696
v_mfma_f32_32x32x16_bf16 v[80:95], v[232:235], v[24:27], v[80:95]
ds_read_b64_tr_b16 v[22:23], v11 offset:30208
s_waitcnt lgkmcnt(4)
v_mfma_f32_32x32x16_bf16 v[64:79], v[172:175], v[28:31], v[64:79]
ds_read_b64_tr_b16 v[24:25], v11 offset:30720
v_mfma_f32_32x32x16_bf16 v[80:95], v[236:239], v[28:31], v[80:95]
ds_read_b64_tr_b16 v[26:27], v11 offset:31232
s_waitcnt lgkmcnt(4)
v_mfma_f32_32x32x16_bf16 v[64:79], v[176:179], v[16:19], v[64:79]
ds_read_b64_tr_b16 v[28:29], v11 offset:31744
v_mfma_f32_32x32x16_bf16 v[80:95], v[240:243], v[16:19], v[80:95]
ds_read_b64_tr_b16 v[30:31], v11 offset:32256
s_waitcnt lgkmcnt(4)
v_mfma_f32_32x32x16_bf16 v[64:79], v[180:183], v[20:23], v[64:79]
ds_read_b64_tr_b16 v[16:17], v11 offset:32768
v_mfma_f32_32x32x16_bf16 v[80:95], v[244:247], v[20:23], v[80:95]
ds_read_b64_tr_b16 v[18:19], v11 offset:33280
s_waitcnt lgkmcnt(4)
v_mfma_f32_32x32x16_bf16 v[64:79], v[184:187], v[24:27], v[64:79]
ds_read_b64_tr_b16 v[20:21], v11 offset:33792
v_mfma_f32_32x32x16_bf16 v[80:95], v[248:251], v[24:27], v[80:95]
ds_read_b64_tr_b16 v[22:23], v11 offset:34304
s_waitcnt lgkmcnt(4)
v_mfma_f32_32x32x16_bf16 v[64:79], v[188:191], v[28:31], v[64:79]
s_nop 1
ds_read_b64_tr_b16 v[24:25], v11 offset:34816
v_mfma_f32_32x32x16_bf16 v[80:95], v[252:255], v[28:31], v[80:95]
s_nop 0
ds_read_b64_tr_b16 v[26:27], v11 offset:35328
s_waitcnt lgkmcnt(4)
v_mfma_f32_32x32x16_bf16 v[96:111], v[128:131], v[16:19], 0
s_nop 0
ds_read_b64_tr_b16 v[28:29], v11 offset:35840
v_mfma_f32_32x32x16_bf16 v[112:127], v[192:195], v[16:19], 0
ds_read_b64_tr_b16 v[30:31], v11 offset:36352
v_cvt_pk_bf16_f32 v64, v64, v65
s_waitcnt lgkmcnt(4)
v_mfma_f32_32x32x16_bf16 v[96:111], v[132:135], v[20:23], v[96:111]
ds_read_b64_tr_b16 v[16:17], v11 offset:36864
v_cvt_pk_bf16_f32 v65, v66, v67
v_cvt_pk_bf16_f32 v66, v68, v69
v_mfma_f32_32x32x16_bf16 v[112:127], v[196:199], v[20:23], v[112:127]
ds_read_b64_tr_b16 v[18:19], v11 offset:37376
v_cvt_pk_bf16_f32 v67, v70, v71
s_waitcnt lgkmcnt(4)
v_mfma_f32_32x32x16_bf16 v[96:111], v[136:139], v[24:27], v[96:111]
ds_read_b64_tr_b16 v[20:21], v11 offset:37888
ds_write_b128 v12, v[64:67]
v_mfma_f32_32x32x16_bf16 v[112:127], v[200:203], v[24:27], v[112:127]
ds_read_b64_tr_b16 v[22:23], v11 offset:38400
v_cvt_pk_bf16_f32 v68, v72, v73
s_waitcnt lgkmcnt(5)
v_mfma_f32_32x32x16_bf16 v[96:111], v[140:143], v[28:31], v[96:111]
ds_read_b64_tr_b16 v[24:25], v11 offset:38912
v_cvt_pk_bf16_f32 v69, v74, v75
v_cvt_pk_bf16_f32 v70, v76, v77
v_mfma_f32_32x32x16_bf16 v[112:127], v[204:207], v[28:31], v[112:127]
ds_read_b64_tr_b16 v[26:27], v11 offset:39424
v_cvt_pk_bf16_f32 v71, v78, v79
s_waitcnt lgkmcnt(5)
v_mfma_f32_32x32x16_bf16 v[96:111], v[144:147], v[16:19], v[96:111]
ds_read_b64_tr_b16 v[28:29], v11 offset:39936
ds_write_b128 v0, v[68:71]
v_mfma_f32_32x32x16_bf16 v[112:127], v[208:211], v[16:19], v[112:127]
ds_read_b64_tr_b16 v[30:31], v11 offset:40448
v_cvt_pk_bf16_f32 v80, v80, v81
s_waitcnt lgkmcnt(5)
v_mfma_f32_32x32x16_bf16 v[96:111], v[148:151], v[20:23], v[96:111]
s_barrier
ds_read_b64_tr_b16 v[16:17], v11 offset:40960
v_cvt_pk_bf16_f32 v81, v82, v83
v_cvt_pk_bf16_f32 v82, v84, v85
v_mfma_f32_32x32x16_bf16 v[112:127], v[212:215], v[20:23], v[112:127]
ds_read_b64_tr_b16 v[18:19], v11 offset:41472
v_cvt_pk_bf16_f32 v83, v86, v87
s_waitcnt lgkmcnt(5)
v_mfma_f32_32x32x16_bf16 v[96:111], v[152:155], v[24:27], v[96:111]
ds_read_b64_tr_b16 v[20:21], v11 offset:41984
ds_write_b128 v1, v[80:83]
v_mfma_f32_32x32x16_bf16 v[112:127], v[216:219], v[24:27], v[112:127]
ds_read_b64_tr_b16 v[22:23], v11 offset:42496
v_cvt_pk_bf16_f32 v84, v88, v89
s_waitcnt lgkmcnt(5)
v_mfma_f32_32x32x16_bf16 v[96:111], v[156:159], v[28:31], v[96:111]
ds_read_b64_tr_b16 v[24:25], v11 offset:43008
v_cvt_pk_bf16_f32 v85, v90, v91
v_cvt_pk_bf16_f32 v86, v92, v93
v_mfma_f32_32x32x16_bf16 v[112:127], v[220:223], v[28:31], v[112:127]
ds_read_b64_tr_b16 v[26:27], v11 offset:43520
v_cvt_pk_bf16_f32 v87, v94, v95
s_waitcnt lgkmcnt(5)
v_mfma_f32_32x32x16_bf16 v[96:111], v[160:163], v[16:19], v[96:111]
ds_read_b64_tr_b16 v[28:29], v11 offset:44032
ds_write_b128 v9, v[84:87]
v_mfma_f32_32x32x16_bf16 v[112:127], v[224:227], v[16:19], v[112:127]
ds_read_b64_tr_b16 v[30:31], v11 offset:44544
s_waitcnt lgkmcnt(5)
v_mfma_f32_32x32x16_bf16 v[96:111], v[164:167], v[20:23], v[96:111]
ds_read_b64_tr_b16 v[16:17], v11 offset:45056
ds_read_b128 v[72:75], v13 offset:0
ds_read_b128 v[76:79], v13 offset:1024
v_mfma_f32_32x32x16_bf16 v[112:127], v[228:231], v[20:23], v[112:127]
ds_read_b64_tr_b16 v[18:19], v11 offset:45568
s_waitcnt lgkmcnt(7)
v_mfma_f32_32x32x16_bf16 v[96:111], v[168:171], v[24:27], v[96:111]
ds_read_b64_tr_b16 v[20:21], v11 offset:46080
ds_read_b128 v[88:91], v13 offset:2048
ds_read_b128 v[92:95], v13 offset:3072
v_mfma_f32_32x32x16_bf16 v[112:127], v[232:235], v[24:27], v[112:127]
ds_read_b64_tr_b16 v[22:23], v11 offset:46592
s_waitcnt lgkmcnt(8)
v_mfma_f32_32x32x16_bf16 v[96:111], v[172:175], v[28:31], v[96:111]
ds_read_b64_tr_b16 v[24:25], v11 offset:47104
v_mfma_f32_32x32x16_bf16 v[112:127], v[236:239], v[28:31], v[112:127]
ds_read_b64_tr_b16 v[26:27], v11 offset:47616
s_waitcnt lgkmcnt(6)
v_mfma_f32_32x32x16_bf16 v[96:111], v[176:179], v[16:19], v[96:111]
ds_read_b64_tr_b16 v[28:29], v11 offset:48128
s_movk_i32 s38, 16384
buffer_store_dwordx4 v[72:75], v14, s[20:23], s38 offen sc1 nt
v_mfma_f32_32x32x16_bf16 v[112:127], v[240:243], v[16:19], v[112:127]
ds_read_b64_tr_b16 v[30:31], v11 offset:48640
s_waitcnt lgkmcnt(4)
v_mfma_f32_32x32x16_bf16 v[96:111], v[180:183], v[20:23], v[96:111]
ds_read_b64_tr_b16 v[16:17], v11 offset:49152
s_movk_i32 s38, 20480
buffer_store_dwordx4 v[76:79], v14, s[20:23], s38 offen sc1 nt
v_mfma_f32_32x32x16_bf16 v[112:127], v[244:247], v[20:23], v[112:127]
ds_read_b64_tr_b16 v[18:19], v11 offset:49664
s_waitcnt lgkmcnt(4)
v_mfma_f32_32x32x16_bf16 v[96:111], v[184:187], v[24:27], v[96:111]
ds_read_b64_tr_b16 v[20:21], v11 offset:50176
s_mov_b32 s38, 39936
buffer_store_dwordx4 v[88:91], v14, s[20:23], s38 offen sc1 nt
v_mfma_f32_32x32x16_bf16 v[112:127], v[248:251], v[24:27], v[112:127]
ds_read_b64_tr_b16 v[22:23], v11 offset:50688
s_waitcnt lgkmcnt(4)
v_mfma_f32_32x32x16_bf16 v[96:111], v[188:191], v[28:31], v[96:111]
s_nop 0
ds_read_b64_tr_b16 v[24:25], v11 offset:51200
s_mov_b32 s38, 44032
buffer_store_dwordx4 v[92:95], v14, s[20:23], s38 offen sc1 nt
v_mfma_f32_32x32x16_bf16 v[112:127], v[252:255], v[28:31], v[112:127]
s_nop 0
ds_read_b64_tr_b16 v[26:27], v11 offset:51712
s_waitcnt lgkmcnt(4)
v_mfma_f32_32x32x16_bf16 v[32:47], v[128:131], v[16:19], 0
ds_read_b64_tr_b16 v[28:29], v11 offset:52224
v_mfma_f32_32x32x16_bf16 v[48:63], v[192:195], v[16:19], 0
ds_read_b64_tr_b16 v[30:31], v11 offset:52736
v_cvt_pk_bf16_f32 v96, v96, v97
v_cvt_pk_bf16_f32 v97, v98, v99
v_cvt_pk_bf16_f32 v98, v100, v101
v_cvt_pk_bf16_f32 v99, v102, v103
s_waitcnt lgkmcnt(4)
v_mfma_f32_32x32x16_bf16 v[32:47], v[132:135], v[20:23], v[32:47]
ds_read_b64_tr_b16 v[16:17], v11 offset:53248
ds_write_b128 v12, v[96:99]
v_mfma_f32_32x32x16_bf16 v[48:63], v[196:199], v[20:23], v[48:63]
ds_read_b64_tr_b16 v[18:19], v11 offset:53760
v_cvt_pk_bf16_f32 v100, v104, v105
v_cvt_pk_bf16_f32 v101, v106, v107
v_cvt_pk_bf16_f32 v102, v108, v109
v_cvt_pk_bf16_f32 v103, v110, v111
s_waitcnt lgkmcnt(5)
v_mfma_f32_32x32x16_bf16 v[32:47], v[136:139], v[24:27], v[32:47]
ds_read_b64_tr_b16 v[20:21], v11 offset:54272
ds_write_b128 v0, v[100:103]
v_mfma_f32_32x32x16_bf16 v[48:63], v[200:203], v[24:27], v[48:63]
ds_read_b64_tr_b16 v[22:23], v11 offset:54784
v_cvt_pk_bf16_f32 v112, v112, v113
v_cvt_pk_bf16_f32 v113, v114, v115
v_cvt_pk_bf16_f32 v114, v116, v117
v_cvt_pk_bf16_f32 v115, v118, v119
s_waitcnt lgkmcnt(6)
v_mfma_f32_32x32x16_bf16 v[32:47], v[140:143], v[28:31], v[32:47]
ds_read_b64_tr_b16 v[24:25], v11 offset:55296
ds_write_b128 v1, v[112:115]
v_mfma_f32_32x32x16_bf16 v[48:63], v[204:207], v[28:31], v[48:63]
ds_read_b64_tr_b16 v[26:27], v11 offset:55808
v_cvt_pk_bf16_f32 v116, v120, v121
v_cvt_pk_bf16_f32 v117, v122, v123
v_cvt_pk_bf16_f32 v118, v124, v125
v_cvt_pk_bf16_f32 v119, v126, v127
s_waitcnt lgkmcnt(6)
v_mfma_f32_32x32x16_bf16 v[32:47], v[144:147], v[16:19], v[32:47]
ds_read_b64_tr_b16 v[28:29], v11 offset:56320
ds_write_b128 v9, v[116:119]
v_mfma_f32_32x32x16_bf16 v[48:63], v[208:211], v[16:19], v[48:63]
ds_read_b64_tr_b16 v[30:31], v11 offset:56832
ds_read_b128 v[104:107], v13 offset:0
ds_read_b128 v[108:111], v13 offset:1024
s_waitcnt lgkmcnt(8)
v_mfma_f32_32x32x16_bf16 v[32:47], v[148:151], v[20:23], v[32:47]
ds_read_b128 v[120:123], v13 offset:2048
ds_read_b128 v[124:127], v13 offset:3072
v_mfma_f32_32x32x16_bf16 v[48:63], v[212:215], v[20:23], v[48:63]
s_waitcnt lgkmcnt(7)
v_mfma_f32_32x32x16_bf16 v[32:47], v[152:155], v[24:27], v[32:47]
s_barrier
ds_read_b64_tr_b16 v[64:65], v11 offset:57344
ds_read_b64_tr_b16 v[66:67], v11 offset:57856
ds_read_b64_tr_b16 v[68:69], v11 offset:58368
ds_read_b64_tr_b16 v[70:71], v11 offset:58880
v_mfma_f32_32x32x16_bf16 v[48:63], v[216:219], v[24:27], v[48:63]
ds_read_b64_tr_b16 v[72:73], v11 offset:59392
ds_read_b64_tr_b16 v[74:75], v11 offset:59904
ds_read_b64_tr_b16 v[76:77], v11 offset:60416
ds_read_b64_tr_b16 v[78:79], v11 offset:60928
s_waitcnt lgkmcnt(12)
v_mfma_f32_32x32x16_bf16 v[32:47], v[156:159], v[28:31], v[32:47]
ds_read_b64_tr_b16 v[80:81], v11 offset:61440
ds_read_b64_tr_b16 v[82:83], v11 offset:61952
ds_read_b64_tr_b16 v[84:85], v11 offset:62464
ds_read_b64_tr_b16 v[86:87], v11 offset:62976
v_mfma_f32_32x32x16_bf16 v[48:63], v[220:223], v[28:31], v[48:63]
ds_read_b64_tr_b16 v[88:89], v11 offset:63488
ds_read_b64_tr_b16 v[90:91], v11 offset:64000
ds_read_b64_tr_b16 v[92:93], v11 offset:64512
ds_read_b64_tr_b16 v[94:95], v11 offset:65024
s_waitcnt lgkmcnt(14)
v_mfma_f32_32x32x16_bf16 v[32:47], v[160:163], v[64:67], v[32:47]
s_movk_i32 s38, 8192
buffer_store_dwordx4 v[104:107], v14, s[20:23], s38 offen sc1 nt
s_waitcnt lgkmcnt(12)
v_mfma_f32_32x32x16_bf16 v[32:47], v[164:167], v[68:71], v[32:47]
s_movk_i32 s38, 12288
buffer_store_dwordx4 v[108:111], v14, s[20:23], s38 offen sc1 nt
s_waitcnt lgkmcnt(10)
v_mfma_f32_32x32x16_bf16 v[32:47], v[168:171], v[72:75], v[32:47]
s_mov_b32 s38, 48128
buffer_store_dwordx4 v[120:123], v14, s[20:23], s38 offen sc1 nt
s_waitcnt lgkmcnt(8)
v_mfma_f32_32x32x16_bf16 v[32:47], v[172:175], v[76:79], v[32:47]
s_mov_b32 s38, 52224
buffer_store_dwordx4 v[124:127], v14, s[20:23], s38 offen sc1 nt
s_waitcnt lgkmcnt(6)
v_mfma_f32_32x32x16_bf16 v[32:47], v[176:179], v[80:83], v[32:47]
s_waitcnt lgkmcnt(4)
v_mfma_f32_32x32x16_bf16 v[32:47], v[180:183], v[84:87], v[32:47]
s_waitcnt lgkmcnt(2)
v_mfma_f32_32x32x16_bf16 v[32:47], v[184:187], v[88:91], v[32:47]
s_waitcnt lgkmcnt(0)
v_mfma_f32_32x32x16_bf16 v[32:47], v[188:191], v[92:95], v[32:47]
s_nop 2
v_mfma_f32_32x32x16_bf16 v[48:63], v[224:227], v[64:67], v[48:63]
s_nop 2
v_mfma_f32_32x32x16_bf16 v[48:63], v[228:231], v[68:71], v[48:63]
s_nop 2
v_mfma_f32_32x32x16_bf16 v[48:63], v[232:235], v[72:75], v[48:63]
v_cvt_pk_bf16_f32 v32, v32, v33
v_cvt_pk_bf16_f32 v33, v34, v35
v_cvt_pk_bf16_f32 v34, v36, v37
v_cvt_pk_bf16_f32 v35, v38, v39
v_mfma_f32_32x32x16_bf16 v[48:63], v[236:239], v[76:79], v[48:63]
ds_write_b128 v12, v[32:35]
v_mfma_f32_32x32x16_bf16 v[48:63], v[240:243], v[80:83], v[48:63]
v_cvt_pk_bf16_f32 v36, v40, v41
v_cvt_pk_bf16_f32 v37, v42, v43
v_cvt_pk_bf16_f32 v38, v44, v45
v_cvt_pk_bf16_f32 v39, v46, v47
v_mfma_f32_32x32x16_bf16 v[48:63], v[244:247], v[84:87], v[48:63]
ds_write_b128 v0, v[36:39]
v_mfma_f32_32x32x16_bf16 v[48:63], v[248:251], v[88:91], v[48:63]
v_mfma_f32_32x32x16_bf16 v[48:63], v[252:255], v[92:95], v[48:63]
s_nop 11
v_cvt_pk_bf16_f32 v48, v48, v49
v_cvt_pk_bf16_f32 v49, v50, v51
v_cvt_pk_bf16_f32 v50, v52, v53
v_cvt_pk_bf16_f32 v51, v54, v55
ds_write_b128 v1, v[48:51]
v_cvt_pk_bf16_f32 v52, v56, v57
v_cvt_pk_bf16_f32 v53, v58, v59
v_cvt_pk_bf16_f32 v54, v60, v61
v_cvt_pk_bf16_f32 v55, v62, v63
ds_write_b128 v9, v[52:55]
ds_read_b128 v[40:43], v13 offset:0
ds_read_b128 v[44:47], v13 offset:1024
ds_read_b128 v[56:59], v13 offset:2048
ds_read_b128 v[60:63], v13 offset:3072
s_movk_i32 s38, 0
s_waitcnt lgkmcnt(3)
buffer_store_dwordx4 v[40:43], v14, s[20:23], s38 offen sc1
s_movk_i32 s38, 4096
s_waitcnt lgkmcnt(2)
buffer_store_dwordx4 v[44:47], v14, s[20:23], s38 offen sc1
s_mov_b32 s38, 56320
s_waitcnt lgkmcnt(1)
buffer_store_dwordx4 v[56:59], v14, s[20:23], s38 offen sc1
s_mov_b32 s38, 60416
s_waitcnt lgkmcnt(0)
buffer_store_dwordx4 v[60:63], v14, s[20:23], s38 offen sc1
s_endpgm
.p2align 6
L_grp_b:
s_waitcnt vmcnt(0)
v_lshlrev_b32 v5, 16, v5
v_lshlrev_b32 v6, 16, v6
v_lshlrev_b32 v7, 16, v7
v_mul_f32 v5, v8, v5
v_mul_f32 v6, v8, v6
v_mul_f32 v7, v8, v7
s_lshl_b32 s31, s3, 13
s_lshl_b32 s39, s29, 7
s_add_u32 s16, s16, s39
s_addc_u32 s17, s17, 0
s_sub_u32 s18, 131072, s39
s_mov_b32 s19, 0x20000
v_lshrrev_b32 v19, 2, v17
v_lshl_add_u32 v19, v19, 3, v18
v_lshl_add_u32 v19, v19, 2, v25
v_lshlrev_b32 v58, 4, v19
v_lshlrev_b32 v13, 9, v17
s_lshl_b32 s38, s47, 14
s_setprio 0
s_barrier
s_add_u32 m0, s35, 0
s_xor_b32 s37, s30, 0
buffer_load_dwordx4 v9, s[12:15], s37 offen lds
s_add_u32 m0, s35, 512
s_nop 0
buffer_load_dwordx4 v9, s[12:15], s37 offen offset:512 lds
s_add_u32 m0, s35, 2048
s_xor_b32 s37, s30, 16384
buffer_load_dwordx4 v9, s[12:15], s37 offen lds
s_add_u32 m0, s35, 2560
s_nop 0
buffer_load_dwordx4 v9, s[12:15], s37 offen offset:512 lds
s_add_u32 m0, s35, 4096
s_xor_b32 s37, s30, 32768
buffer_load_dwordx4 v9, s[12:15], s37 offen lds
s_add_u32 m0, s35, 4608
s_nop 0
buffer_load_dwordx4 v9, s[12:15], s37 offen offset:512 lds
s_add_u32 m0, s35, 6144
s_xor_b32 s37, s30, 49152
buffer_load_dwordx4 v9, s[12:15], s37 offen lds
s_add_u32 m0, s35, 6656
s_nop 0
buffer_load_dwordx4 v9, s[12:15], s37 offen offset:512 lds
s_add_u32 m0, s35, 8192
s_xor_b32 s37, s30, 65536
buffer_load_dwordx4 v9, s[12:15], s37 offen lds
s_add_u32 m0, s35, 8704
s_nop 0
buffer_load_dwordx4 v9, s[12:15], s37 offen offset:512 lds
s_add_u32 m0, s35, 10240
s_xor_b32 s37, s30, 81920
buffer_load_dwordx4 v9, s[12:15], s37 offen lds
s_add_u32 m0, s35, 10752
s_nop 0
buffer_load_dwordx4 v9, s[12:15], s37 offen offset:512 lds
s_waitcnt vmcnt(11)
ds_read_b64_tr_b16 v[128:129], v10 offset:0
ds_read_b64_tr_b16 v[130:131], v10 offset:256
s_waitcnt vmcnt(10)
ds_read_b64_tr_b16 v[192:193], v10 offset:1024
ds_read_b64_tr_b16 v[194:195], v10 offset:1280
ds_read_b128 v[32:35], v0 offset:0
ds_read_b128 v[36:39], v0 offset:16384
s_waitcnt vmcnt(9)
ds_read_b64_tr_b16 v[132:133], v10 offset:2048
ds_read_b64_tr_b16 v[134:135], v10 offset:2304
s_waitcnt vmcnt(8)
ds_read_b64_tr_b16 v[196:197], v10 offset:3072
ds_read_b64_tr_b16 v[198:199], v10 offset:3328
ds_read_b128 v[40:43], v1 offset:0
ds_read_b128 v[44:47], v1 offset:16384
s_setprio 2
s_waitcnt lgkmcnt(6)
v_mfma_f32_32x32x16_bf16 v[80:95], v[32:35], v[192:195], 0
s_add_u32 m0, s35, 12288
s_xor_b32 s37, s30, 98304
buffer_load_dwordx4 v9, s[12:15], s37 offen lds
s_add_u32 m0, s35, 12800
v_mfma_f32_32x32x16_bf16 v[64:79], v[32:35], v[128:131], 0
s_waitcnt vmcnt(8)
ds_read_b64_tr_b16 v[136:137], v10 offset:4096
ds_read_b64_tr_b16 v[138:139], v10 offset:4352
ds_read_b128 v[48:51], v0 offset:256
v_mfma_f32_32x32x16_bf16 v[112:127], v[36:39], v[192:195], 0
buffer_load_dwordx4 v9, s[12:15], s37 offen offset:512 lds
v_mfma_f32_32x32x16_bf16 v[96:111], v[36:39], v[128:131], 0
s_waitcnt vmcnt(8)
ds_read_b64_tr_b16 v[200:201], v10 offset:5120
ds_read_b64_tr_b16 v[202:203], v10 offset:5376
ds_read_b128 v[52:55], v0 offset:16640
s_waitcnt lgkmcnt(6)
v_mfma_f32_32x32x16_bf16 v[80:95], v[40:43], v[196:199], v[80:95]
s_add_u32 m0, s35, 14336
s_xor_b32 s37, s30, 114688
buffer_load_dwordx4 v9, s[12:15], s37 offen lds
s_add_u32 m0, s35, 14848
v_mfma_f32_32x32x16_bf16 v[64:79], v[40:43], v[132:135], v[64:79]
s_waitcnt vmcnt(8)
ds_read_b64_tr_b16 v[140:141], v10 offset:6144
ds_read_b64_tr_b16 v[142:143], v10 offset:6400
ds_read_b128 v[32:35], v1 offset:256
v_mfma_f32_32x32x16_bf16 v[112:127], v[44:47], v[196:199], v[112:127]
buffer_load_dwordx4 v9, s[12:15], s37 offen offset:512 lds
v_mfma_f32_32x32x16_bf16 v[96:111], v[44:47], v[132:135], v[96:111]
s_waitcnt vmcnt(8)
ds_read_b64_tr_b16 v[204:205], v10 offset:7168
ds_read_b64_tr_b16 v[206:207], v10 offset:7424
ds_read_b128 v[36:39], v1 offset:16640
s_waitcnt lgkmcnt(6)
v_mfma_f32_32x32x16_bf16 v[80:95], v[48:51], v[200:203], v[80:95]
s_add_u32 m0, s35, 0
s_xor_b32 s37, s30, 131072
buffer_load_dwordx4 v9, s[12:15], s37 offen lds
s_add_u32 m0, s35, 512
v_mfma_f32_32x32x16_bf16 v[64:79], v[48:51], v[136:139], v[64:79]
s_waitcnt vmcnt(8)
ds_read_b64_tr_b16 v[144:145], v10 offset:8192
ds_read_b64_tr_b16 v[146:147], v10 offset:8448
ds_read_b128 v[40:43], v0 offset:512
v_mfma_f32_32x32x16_bf16 v[112:127], v[52:55], v[200:203], v[112:127]
buffer_load_dwordx4 v9, s[12:15], s37 offen offset:512 lds
v_mfma_f32_32x32x16_bf16 v[96:111], v[52:55], v[136:139], v[96:111]
s_waitcnt vmcnt(8)
ds_read_b64_tr_b16 v[208:209], v10 offset:9216
ds_read_b64_tr_b16 v[210:211], v10 offset:9472
ds_read_b128 v[44:47], v0 offset:16896
s_barrier
s_waitcnt lgkmcnt(6)
v_mfma_f32_32x32x16_bf16 v[80:95], v[32:35], v[204:207], v[80:95]
s_add_u32 m0, s35, 2048
s_xor_b32 s37, s30, 147456
buffer_load_dwordx4 v9, s[12:15], s37 offen lds
s_add_u32 m0, s35, 2560
v_mfma_f32_32x32x16_bf16 v[64:79], v[32:35], v[140:143], v[64:79]
s_waitcnt vmcnt(8)
ds_read_b64_tr_b16 v[148:149], v10 offset:10240
ds_read_b64_tr_b16 v[150:151], v10 offset:10496
ds_read_b128 v[48:51], v1 offset:512
v_mfma_f32_32x32x16_bf16 v[112:127], v[36:39], v[204:207], v[112:127]
buffer_load_dwordx4 v9, s[12:15], s37 offen offset:512 lds
v_mfma_f32_32x32x16_bf16 v[96:111], v[36:39], v[140:143], v[96:111]
s_waitcnt vmcnt(8)
ds_read_b64_tr_b16 v[212:213], v10 offset:11264
ds_read_b64_tr_b16 v[214:215], v10 offset:11520
ds_read_b128 v[52:55], v1 offset:16896
s_waitcnt lgkmcnt(6)
v_mfma_f32_32x32x16_bf16 v[80:95], v[40:43], v[208:211], v[80:95]
s_add_u32 m0, s35, 4096
s_xor_b32 s37, s30, 163840
buffer_load_dwordx4 v9, s[12:15], s37 offen lds
s_add_u32 m0, s35, 4608
v_mfma_f32_32x32x16_bf16 v[64:79], v[40:43], v[144:147], v[64:79]
s_waitcnt vmcnt(8)
ds_read_b64_tr_b16 v[152:153], v10 offset:12288
ds_read_b64_tr_b16 v[154:155], v10 offset:12544
ds_read_b128 v[32:35], v0 offset:768
v_mfma_f32_32x32x16_bf16 v[112:127], v[44:47], v[208:211], v[112:127]
buffer_load_dwordx4 v9, s[12:15], s37 offen offset:512 lds
v_mfma_f32_32x32x16_bf16 v[96:111], v[44:47], v[144:147], v[96:111]
s_waitcnt vmcnt(8)
ds_read_b64_tr_b16 v[216:217], v10 offset:13312
ds_read_b64_tr_b16 v[218:219], v10 offset:13568
ds_read_b128 v[36:39], v0 offset:17152
s_waitcnt lgkmcnt(6)
v_mfma_f32_32x32x16_bf16 v[80:95], v[48:51], v[212:215], v[80:95]
s_add_u32 m0, s35, 6144
s_xor_b32 s37, s30, 180224
buffer_load_dwordx4 v9, s[12:15], s37 offen lds
s_add_u32 m0, s35, 6656
v_mfma_f32_32x32x16_bf16 v[64:79], v[48:51], v[148:151], v[64:79]
s_waitcnt vmcnt(8)
ds_read_b64_tr_b16 v[156:157], v10 offset:14336
ds_read_b64_tr_b16 v[158:159], v10 offset:14592
ds_read_b128 v[40:43], v1 offset:768
v_mfma_f32_32x32x16_bf16 v[112:127], v[52:55], v[212:215], v[112:127]
buffer_load_dwordx4 v9, s[12:15], s37 offen offset:512 lds
v_mfma_f32_32x32x16_bf16 v[96:111], v[52:55], v[148:151], v[96:111]
s_waitcnt vmcnt(8)
ds_read_b64_tr_b16 v[220:221], v10 offset:15360
ds_read_b64_tr_b16 v[222:223], v10 offset:15616
ds_read_b128 v[44:47], v1 offset:17152
s_waitcnt lgkmcnt(6)
v_mfma_f32_32x32x16_bf16 v[80:95], v[32:35], v[216:219], v[80:95]
s_add_u32 m0, s35, 8192
s_xor_b32 s37, s30, 196608
buffer_load_dwordx4 v9, s[12:15], s37 offen lds
s_add_u32 m0, s35, 8704
v_mfma_f32_32x32x16_bf16 v[64:79], v[32:35], v[152:155], v[64:79]
s_waitcnt vmcnt(8)
ds_read_b64_tr_b16 v[160:161], v10 offset:0
ds_read_b64_tr_b16 v[162:163], v10 offset:256
ds_read_b128 v[48:51], v0 offset:1024
v_mfma_f32_32x32x16_bf16 v[112:127], v[36:39], v[216:219], v[112:127]
buffer_load_dwordx4 v9, s[12:15], s37 offen offset:512 lds
v_mfma_f32_32x32x16_bf16 v[96:111], v[36:39], v[152:155], v[96:111]
s_waitcnt vmcnt(8)
ds_read_b64_tr_b16 v[224:225], v10 offset:1024
ds_read_b64_tr_b16 v[226:227], v10 offset:1280
ds_read_b128 v[52:55], v0 offset:17408
s_waitcnt lgkmcnt(6)
v_mfma_f32_32x32x16_bf16 v[80:95], v[40:43], v[220:223], v[80:95]
s_add_u32 m0, s35, 10240
s_xor_b32 s37, s30, 212992
buffer_load_dwordx4 v9, s[12:15], s37 offen lds
s_add_u32 m0, s35, 10752
v_mfma_f32_32x32x16_bf16 v[64:79], v[40:43], v[156:159], v[64:79]
s_waitcnt vmcnt(8)
ds_read_b64_tr_b16 v[164:165], v10 offset:2048
ds_read_b64_tr_b16 v[166:167], v10 offset:2304
ds_read_b128 v[32:35], v1 offset:1024
v_mfma_f32_32x32x16_bf16 v[112:127], v[44:47], v[220:223], v[112:127]
buffer_load_dwordx4 v9, s[12:15], s37 offen offset:512 lds
v_mfma_f32_32x32x16_bf16 v[96:111], v[44:47], v[156:159], v[96:111]
s_waitcnt vmcnt(8)
ds_read_b64_tr_b16 v[228:229], v10 offset:3072
ds_read_b64_tr_b16 v[230:231], v10 offset:3328
ds_read_b128 v[36:39], v1 offset:17408
s_waitcnt lgkmcnt(6)
v_mfma_f32_32x32x16_bf16 v[80:95], v[48:51], v[224:227], v[80:95]
s_add_u32 m0, s35, 12288
s_xor_b32 s37, s30, 229376
buffer_load_dwordx4 v9, s[12:15], s37 offen lds
s_add_u32 m0, s35, 12800
v_mfma_f32_32x32x16_bf16 v[64:79], v[48:51], v[160:163], v[64:79]
s_waitcnt vmcnt(8)
ds_read_b64_tr_b16 v[168:169], v10 offset:4096
ds_read_b64_tr_b16 v[170:171], v10 offset:4352
ds_read_b128 v[40:43], v0 offset:1280
v_mfma_f32_32x32x16_bf16 v[112:127], v[52:55], v[224:227], v[112:127]
buffer_load_dwordx4 v9, s[12:15], s37 offen offset:512 lds
v_mfma_f32_32x32x16_bf16 v[96:111], v[52:55], v[160:163], v[96:111]
s_waitcnt vmcnt(8)
ds_read_b64_tr_b16 v[232:233], v10 offset:5120
ds_read_b64_tr_b16 v[234:235], v10 offset:5376
ds_read_b128 v[44:47], v0 offset:17664
s_waitcnt lgkmcnt(6)
v_mfma_f32_32x32x16_bf16 v[80:95], v[32:35], v[228:231], v[80:95]
s_add_u32 m0, s35, 14336
s_xor_b32 s37, s30, 245760
buffer_load_dwordx4 v9, s[12:15], s37 offen lds
s_add_u32 m0, s35, 14848
v_mfma_f32_32x32x16_bf16 v[64:79], v[32:35], v[164:167], v[64:79]
s_waitcnt vmcnt(8)
ds_read_b64_tr_b16 v[172:173], v10 offset:6144
ds_read_b64_tr_b16 v[174:175], v10 offset:6400
ds_read_b128 v[48:51], v1 offset:1280
v_mfma_f32_32x32x16_bf16 v[112:127], v[36:39], v[228:231], v[112:127]
buffer_load_dwordx4 v9, s[12:15], s37 offen offset:512 lds
v_mfma_f32_32x32x16_bf16 v[96:111], v[36:39], v[164:167], v[96:111]
s_waitcnt vmcnt(8)
ds_read_b64_tr_b16 v[236:237], v10 offset:7168
ds_read_b64_tr_b16 v[238:239], v10 offset:7424
ds_read_b128 v[52:55], v1 offset:17664
s_add_u32 m0, s34, 0
s_nop 0
buffer_load_dwordx4 v56, s[8:11], s32 offen nt lds
s_waitcnt lgkmcnt(6)
v_mfma_f32_32x32x16_bf16 v[80:95], v[40:43], v[232:235], v[80:95]
s_add_u32 m0, s34, 2048
s_nop 0
buffer_load_dwordx4 v57, s[8:11], s32 offen nt lds
v_mfma_f32_32x32x16_bf16 v[64:79], v[40:43], v[168:171], v[64:79]
s_waitcnt vmcnt(9)
ds_read_b64_tr_b16 v[176:177], v10 offset:8192
ds_read_b64_tr_b16 v[178:179], v10 offset:8448
ds_read_b128 v[32:35], v0 offset:1536
s_add_u32 m0, s34, 16384
s_nop 0
buffer_load_dwordx4 v60, s[8:11], s32 offen nt lds
v_mfma_f32_32x32x16_bf16 v[112:127], v[44:47], v[232:235], v[112:127]
s_add_u32 m0, s34, 18432
s_nop 0
buffer_load_dwordx4 v61, s[8:11], s32 offen nt lds
v_mfma_f32_32x32x16_bf16 v[96:111], v[44:47], v[168:171], v[96:111]
s_waitcnt vmcnt(10)
ds_read_b64_tr_b16 v[240:241], v10 offset:9216
ds_read_b64_tr_b16 v[242:243], v10 offset:9472
ds_read_b128 v[36:39], v0 offset:17920
s_add_u32 m0, s34, 1024
s_nop 0
buffer_load_dwordx4 v56, s[8:11], s33 offen nt lds
s_waitcnt lgkmcnt(6)
v_mfma_f32_32x32x16_bf16 v[80:95], v[48:51], v[236:239], v[80:95]
s_add_u32 m0, s34, 3072
s_nop 0
buffer_load_dwordx4 v57, s[8:11], s33 offen nt lds
v_mfma_f32_32x32x16_bf16 v[64:79], v[48:51], v[172:175], v[64:79]
s_waitcnt vmcnt(11)
ds_read_b64_tr_b16 v[180:181], v10 offset:10240
ds_read_b64_tr_b16 v[182:183], v10 offset:10496
ds_read_b128 v[40:43], v1 offset:1536
s_add_u32 m0, s34, 17408
s_nop 0
buffer_load_dwordx4 v60, s[8:11], s33 offen nt lds
v_mfma_f32_32x32x16_bf16 v[112:127], v[52:55], v[236:239], v[112:127]
s_add_u32 m0, s34, 19456
s_nop 0
buffer_load_dwordx4 v61, s[8:11], s33 offen nt lds
v_mfma_f32_32x32x16_bf16 v[96:111], v[52:55], v[172:175], v[96:111]
s_waitcnt vmcnt(12)
ds_read_b64_tr_b16 v[244:245], v10 offset:11264
ds_read_b64_tr_b16 v[246:247], v10 offset:11520
ds_read_b128 v[44:47], v1 offset:17920
buffer_load_dword v12, v13, s[16:19], s38 offen
s_waitcnt lgkmcnt(6)
v_mfma_f32_32x32x16_bf16 v[80:95], v[32:35], v[240:243], v[80:95]
v_mfma_f32_32x32x16_bf16 v[64:79], v[32:35], v[176:179], v[64:79]
s_waitcnt vmcnt(12)
ds_read_b64_tr_b16 v[184:185], v10 offset:12288
ds_read_b64_tr_b16 v[186:187], v10 offset:12544
ds_read_b128 v[48:51], v0 offset:1792
v_mfma_f32_32x32x16_bf16 v[112:127], v[36:39], v[240:243], v[112:127]
v_mfma_f32_32x32x16_bf16 v[96:111], v[36:39], v[176:179], v[96:111]
s_waitcnt vmcnt(11)
ds_read_b64_tr_b16 v[248:249], v10 offset:13312
ds_read_b64_tr_b16 v[250:251], v10 offset:13568
ds_read_b128 v[52:55], v0 offset:18176
s_waitcnt lgkmcnt(6)
v_mfma_f32_32x32x16_bf16 v[80:95], v[40:43], v[244:247], v[80:95]
v_mfma_f32_32x32x16_bf16 v[64:79], v[40:43], v[180:183], v[64:79]
s_waitcnt vmcnt(10)
ds_read_b64_tr_b16 v[188:189], v10 offset:14336
ds_read_b64_tr_b16 v[190:191], v10 offset:14592
ds_read_b128 v[32:35], v1 offset:1792
v_mfma_f32_32x32x16_bf16 v[112:127], v[44:47], v[244:247], v[112:127]
v_mfma_f32_32x32x16_bf16 v[96:111], v[44:47], v[180:183], v[96:111]
s_waitcnt vmcnt(9)
ds_read_b64_tr_b16 v[252:253], v10 offset:15360
ds_read_b64_tr_b16 v[254:255], v10 offset:15616
ds_read_b128 v[36:39], v1 offset:18176
s_waitcnt lgkmcnt(6)
v_mfma_f32_32x32x16_bf16 v[80:95], v[48:51], v[248:251], v[80:95]
v_mfma_f32_32x32x16_bf16 v[64:79], v[48:51], v[184:187], v[64:79]
v_mfma_f32_32x32x16_bf16 v[112:127], v[52:55], v[248:251], v[112:127]
v_mfma_f32_32x32x16_bf16 v[96:111], v[52:55], v[184:187], v[96:111]
s_waitcnt lgkmcnt(0)
v_mfma_f32_32x32x16_bf16 v[80:95], v[32:35], v[252:255], v[80:95]
s_nop 2
v_mfma_f32_32x32x16_bf16 v[64:79], v[32:35], v[188:191], v[64:79]
s_nop 2
v_mfma_f32_32x32x16_bf16 v[112:127], v[36:39], v[252:255], v[112:127]
s_nop 1
v_mfma_f32_32x32x16_bf16 v[96:111], v[36:39], v[188:191], v[96:111]
s_setprio 0
v_mul_f32 v80, v8, v80
v_mul_f32 v81, v8, v81
v_exp_f32 v80, v80
v_exp_f32 v81, v81
v_mul_f32 v82, v8, v82
v_mul_f32 v83, v8, v83
v_add_f32 v80, 1.0, v80
v_add_f32 v81, 1.0, v81
v_exp_f32 v82, v82
v_exp_f32 v83, v83
v_rcp_f32 v80, v80
v_rcp_f32 v81, v81
v_mul_f32 v84, v8, v84
v_mul_f32 v85, v8, v85
v_mul_f32 v64, v64, v80
v_mul_f32 v65, v65, v81
v_mov_b32 v3, v64
v_mov_b32 v4, v64
v_add_f32 v82, 1.0, v82
v_add_f32 v83, 1.0, v83
v_permlane32_swap_b32 v3, v4
v_cndmask_b32 v4, v4, v3, vcc
v_mul_f32 v80, v7, v64
v_mul_f32 v81, v7, v65
v_fmac_f32 v80, v6, v4
v_fmac_f32 v81, v6, v64
v_fmac_f32 v80, v5, v3
v_fmac_f32 v81, v5, v4
v_exp_f32 v84, v84
v_exp_f32 v85, v85
v_rcp_f32 v82, v82
v_rcp_f32 v83, v83
v_exp_f32 v3, v80
v_exp_f32 v4, v81
v_mul_f32 v86, v8, v86
v_mul_f32 v87, v8, v87
v_mul_f32 v66, v66, v82
v_mul_f32 v67, v67, v83
v_add_f32 v84, 1.0, v84
v_add_f32 v85, 1.0, v85
v_mul_f32 v82, v7, v66
v_mul_f32 v83, v7, v67
v_fmac_f32 v82, v6, v65
v_fmac_f32 v83, v6, v66
v_fmac_f32 v82, v5, v64
v_fmac_f32 v83, v5, v65
v_fmaak_f32 v3, v8, v3, 0xbfb8aa3b
v_fmaak_f32 v4, v8, v4, 0xbfb8aa3b
v_exp_f32 v86, v86
v_exp_f32 v87, v87
v_rcp_f32 v84, v84
v_rcp_f32 v85, v85
v_exp_f32 v64, v82
v_exp_f32 v65, v83
v_rcp_f32 v3, v3
v_rcp_f32 v4, v4
s_waitcnt vmcnt(5)
s_barrier
v_mul_f32 v88, v8, v88
v_mul_f32 v89, v8, v89
v_mul_f32 v68, v68, v84
v_mul_f32 v69, v69, v85
v_add_f32 v86, 1.0, v86
v_add_f32 v87, 1.0, v87
v_mul_f32 v84, v7, v68
v_mul_f32 v85, v7, v69
v_fmac_f32 v84, v6, v67
v_fmac_f32 v85, v6, v68
v_fmac_f32 v84, v5, v66
v_fmac_f32 v85, v5, v67
v_fmaak_f32 v64, v8, v64, 0xbfb8aa3b
v_fmaak_f32 v65, v8, v65, 0xbfb8aa3b
v_mul_f32 v80, v80, v3
v_mul_f32 v81, v81, v4
v_exp_f32 v88, v88
v_exp_f32 v89, v89
v_rcp_f32 v86, v86
v_rcp_f32 v87, v87
v_exp_f32 v66, v84
v_exp_f32 v67, v85
v_rcp_f32 v64, v64
v_rcp_f32 v65, v65
v_cvt_pk_bf16_f32 v16, v80, v81
v_mul_f32 v90, v8, v90
v_mul_f32 v91, v8, v91
v_mul_f32 v70, v70, v86
v_mul_f32 v71, v71, v87
v_add_f32 v88, 1.0, v88
v_add_f32 v89, 1.0, v89
v_mul_f32 v86, v7, v70
v_mul_f32 v87, v7, v71
v_fmac_f32 v86, v6, v69
v_fmac_f32 v87, v6, v70
v_fmac_f32 v86, v5, v68
v_fmac_f32 v87, v5, v69
v_fmaak_f32 v66, v8, v66, 0xbfb8aa3b
v_fmaak_f32 v67, v8, v67, 0xbfb8aa3b
v_mul_f32 v82, v82, v64
v_mul_f32 v83, v83, v65
v_exp_f32 v90, v90
v_exp_f32 v91, v91
v_rcp_f32 v88, v88
v_rcp_f32 v89, v89
v_exp_f32 v68, v86
v_exp_f32 v69, v87
v_rcp_f32 v66, v66
v_rcp_f32 v67, v67
v_cvt_pk_bf16_f32 v17, v82, v83
v_mul_f32 v92, v8, v92
v_mul_f32 v93, v8, v93
v_mul_f32 v72, v72, v88
v_mul_f32 v73, v73, v89
v_add_f32 v90, 1.0, v90
v_add_f32 v91, 1.0, v91
v_mul_f32 v88, v7, v72
v_mul_f32 v89, v7, v73
v_fmac_f32 v88, v6, v71
v_fmac_f32 v89, v6, v72
v_fmac_f32 v88, v5, v70
v_fmac_f32 v89, v5, v71
v_fmaak_f32 v68, v8, v68, 0xbfb8aa3b
v_fmaak_f32 v69, v8, v69, 0xbfb8aa3b
v_mul_f32 v84, v84, v66
v_mul_f32 v85, v85, v67
v_exp_f32 v92, v92
v_exp_f32 v93, v93
v_rcp_f32 v90, v90
v_rcp_f32 v91, v91
v_exp_f32 v70, v88
v_exp_f32 v71, v89
v_rcp_f32 v68, v68
v_rcp_f32 v69, v69
v_cvt_pk_bf16_f32 v18, v84, v85
v_mul_f32 v94, v8, v94
v_mul_f32 v95, v8, v95
v_mul_f32 v74, v74, v90
v_mul_f32 v75, v75, v91
v_add_f32 v92, 1.0, v92
v_add_f32 v93, 1.0, v93
v_mul_f32 v90, v7, v74
v_mul_f32 v91, v7, v75
v_fmac_f32 v90, v6, v73
v_fmac_f32 v91, v6, v74
v_fmac_f32 v90, v5, v72
v_fmac_f32 v91, v5, v73
v_fmaak_f32 v70, v8, v70, 0xbfb8aa3b
v_fmaak_f32 v71, v8, v71, 0xbfb8aa3b
v_mul_f32 v86, v86, v68
v_mul_f32 v87, v87, v69
v_exp_f32 v94, v94
v_exp_f32 v95, v95
v_rcp_f32 v92, v92
v_rcp_f32 v93, v93
v_exp_f32 v72, v90
v_exp_f32 v73, v91
v_rcp_f32 v70, v70
v_rcp_f32 v71, v71
v_cvt_pk_bf16_f32 v19, v86, v87
v_mul_f32 v112, v8, v112
v_mul_f32 v113, v8, v113
v_mul_f32 v76, v76, v92
v_mul_f32 v77, v77, v93
v_add_f32 v94, 1.0, v94
v_add_f32 v95, 1.0, v95
v_mul_f32 v92, v7, v76
v_mul_f32 v93, v7, v77
v_fmac_f32 v92, v6, v75
v_fmac_f32 v93, v6, v76
v_fmac_f32 v92, v5, v74
v_fmac_f32 v93, v5, v75
v_fmaak_f32 v72, v8, v72, 0xbfb8aa3b
v_fmaak_f32 v73, v8, v73, 0xbfb8aa3b
v_mul_f32 v88, v88, v70
v_mul_f32 v89, v89, v71
v_exp_f32 v112, v112
v_exp_f32 v113, v113
v_rcp_f32 v94, v94
v_rcp_f32 v95, v95
v_exp_f32 v74, v92
v_exp_f32 v75, v93
v_rcp_f32 v72, v72
v_rcp_f32 v73, v73
v_cvt_pk_bf16_f32 v20, v88, v89
v_mul_f32 v114, v8, v114
v_mul_f32 v115, v8, v115
v_mul_f32 v78, v78, v94
v_mul_f32 v79, v79, v95
v_add_f32 v112, 1.0, v112
v_add_f32 v113, 1.0, v113
v_mul_f32 v94, v7, v78
v_mul_f32 v95, v7, v79
v_fmac_f32 v94, v6, v77
v_fmac_f32 v95, v6, v78
v_fmac_f32 v94, v5, v76
v_fmac_f32 v95, v5, v77
v_fmaak_f32 v74, v8, v74, 0xbfb8aa3b
v_fmaak_f32 v75, v8, v75, 0xbfb8aa3b
v_mul_f32 v90, v90, v72
v_mul_f32 v91, v91, v73
v_exp_f32 v114, v114
v_exp_f32 v115, v115
v_rcp_f32 v112, v112
v_rcp_f32 v113, v113
v_exp_f32 v76, v94
v_exp_f32 v77, v95
v_rcp_f32 v74, v74
v_rcp_f32 v75, v75
v_cvt_pk_bf16_f32 v21, v90, v91
s_setprio 1
s_waitcnt vmcnt(1)
s_barrier
v_mul_f32 v116, v8, v116
v_mul_f32 v117, v8, v117
v_mul_f32 v96, v96, v112
v_mul_f32 v97, v97, v113
v_add_f32 v114, 1.0, v114
v_add_f32 v115, 1.0, v115
v_mul_f32 v112, v7, v96
v_mul_f32 v113, v7, v97
v_fmac_f32 v112, v6, v79
v_fmac_f32 v113, v6, v96
v_fmac_f32 v112, v5, v78
v_fmac_f32 v113, v5, v79
v_fmaak_f32 v76, v8, v76, 0xbfb8aa3b
v_fmaak_f32 v77, v8, v77, 0xbfb8aa3b
v_mul_f32 v92, v92, v74
v_mul_f32 v93, v93, v75
v_exp_f32 v116, v116
v_exp_f32 v117, v117
v_rcp_f32 v114, v114
v_rcp_f32 v115, v115
v_exp_f32 v78, v112
v_exp_f32 v79, v113
v_rcp_f32 v76, v76
v_rcp_f32 v77, v77
v_cvt_pk_bf16_f32 v22, v92, v93
v_mul_f32 v118, v8, v118
v_mul_f32 v119, v8, v119
v_mul_f32 v98, v98, v114
v_mul_f32 v99, v99, v115
v_add_f32 v116, 1.0, v116
v_add_f32 v117, 1.0, v117
v_mul_f32 v114, v7, v98
v_mul_f32 v115, v7, v99
v_fmac_f32 v114, v6, v97
v_fmac_f32 v115, v6, v98
v_fmac_f32 v114, v5, v96
v_fmac_f32 v115, v5, v97
v_fmaak_f32 v78, v8, v78, 0xbfb8aa3b
v_fmaak_f32 v79, v8, v79, 0xbfb8aa3b
v_mul_f32 v94, v94, v76
v_mul_f32 v95, v95, v77
v_exp_f32 v118, v118
v_exp_f32 v119, v119
v_rcp_f32 v116, v116
v_rcp_f32 v117, v117
v_exp_f32 v96, v114
v_exp_f32 v97, v115
v_rcp_f32 v78, v78
v_rcp_f32 v79, v79
v_cvt_pk_bf16_f32 v23, v94, v95
v_mul_f32 v120, v8, v120
v_mul_f32 v121, v8, v121
v_mul_f32 v100, v100, v116
v_mul_f32 v101, v101, v117
v_add_f32 v118, 1.0, v118
v_add_f32 v119, 1.0, v119
v_mul_f32 v116, v7, v100
v_mul_f32 v117, v7, v101
v_fmac_f32 v116, v6, v99
v_fmac_f32 v117, v6, v100
v_fmac_f32 v116, v5, v98
v_fmac_f32 v117, v5, v99
v_fmaak_f32 v96, v8, v96, 0xbfb8aa3b
v_fmaak_f32 v97, v8, v97, 0xbfb8aa3b
v_mul_f32 v112, v112, v78
v_mul_f32 v113, v113, v79
v_exp_f32 v120, v120
v_exp_f32 v121, v121
v_rcp_f32 v118, v118
v_rcp_f32 v119, v119
v_exp_f32 v98, v116
v_exp_f32 v99, v117
v_rcp_f32 v96, v96
v_rcp_f32 v97, v97
v_cvt_pk_bf16_f32 v24, v112, v113
v_mul_f32 v122, v8, v122
v_mul_f32 v123, v8, v123
v_mul_f32 v102, v102, v118
v_mul_f32 v103, v103, v119
v_add_f32 v120, 1.0, v120
v_add_f32 v121, 1.0, v121
v_mul_f32 v118, v7, v102
v_mul_f32 v119, v7, v103
v_fmac_f32 v118, v6, v101
v_fmac_f32 v119, v6, v102
v_fmac_f32 v118, v5, v100
v_fmac_f32 v119, v5, v101
v_fmaak_f32 v98, v8, v98, 0xbfb8aa3b
v_fmaak_f32 v99, v8, v99, 0xbfb8aa3b
v_mul_f32 v114, v114, v96
v_mul_f32 v115, v115, v97
v_exp_f32 v122, v122
v_exp_f32 v123, v123
v_rcp_f32 v120, v120
v_rcp_f32 v121, v121
v_exp_f32 v100, v118
v_exp_f32 v101, v119
v_rcp_f32 v98, v98
v_rcp_f32 v99, v99
v_cvt_pk_bf16_f32 v25, v114, v115
v_mul_f32 v124, v8, v124
v_mul_f32 v125, v8, v125
v_mul_f32 v104, v104, v120
v_mul_f32 v105, v105, v121
v_add_f32 v122, 1.0, v122
v_add_f32 v123, 1.0, v123
v_mul_f32 v120, v7, v104
v_mul_f32 v121, v7, v105
v_fmac_f32 v120, v6, v103
v_fmac_f32 v121, v6, v104
v_fmac_f32 v120, v5, v102
v_fmac_f32 v121, v5, v103
v_fmaak_f32 v100, v8, v100, 0xbfb8aa3b
v_fmaak_f32 v101, v8, v101, 0xbfb8aa3b
v_mul_f32 v116, v116, v98
v_mul_f32 v117, v117, v99
v_exp_f32 v124, v124
v_exp_f32 v125, v125
v_rcp_f32 v122, v122
v_rcp_f32 v123, v123
v_exp_f32 v102, v120
v_exp_f32 v103, v121
v_rcp_f32 v100, v100
v_rcp_f32 v101, v101
v_cvt_pk_bf16_f32 v26, v116, v117
v_mul_f32 v126, v8, v126
v_mul_f32 v127, v8, v127
v_mul_f32 v106, v106, v122
v_mul_f32 v107, v107, v123
v_add_f32 v124, 1.0, v124
v_add_f32 v125, 1.0, v125
v_mul_f32 v122, v7, v106
v_mul_f32 v123, v7, v107
v_fmac_f32 v122, v6, v105
v_fmac_f32 v123, v6, v106
v_fmac_f32 v122, v5, v104
v_fmac_f32 v123, v5, v105
v_fmaak_f32 v102, v8, v102, 0xbfb8aa3b
v_fmaak_f32 v103, v8, v103, 0xbfb8aa3b
v_mul_f32 v118, v118, v100
v_mul_f32 v119, v119, v101
v_exp_f32 v126, v126
v_exp_f32 v127, v127
v_rcp_f32 v124, v124
v_rcp_f32 v125, v125
v_exp_f32 v104, v122
v_exp_f32 v105, v123
v_rcp_f32 v102, v102
v_rcp_f32 v103, v103
v_cvt_pk_bf16_f32 v27, v118, v119
v_mul_f32 v108, v108, v124
v_mul_f32 v109, v109, v125
v_add_f32 v126, 1.0, v126
v_add_f32 v127, 1.0, v127
v_mul_f32 v124, v7, v108
v_mul_f32 v125, v7, v109
v_fmac_f32 v124, v6, v107
v_fmac_f32 v125, v6, v108
v_fmac_f32 v124, v5, v106
v_fmac_f32 v125, v5, v107
v_fmaak_f32 v104, v8, v104, 0xbfb8aa3b
v_fmaak_f32 v105, v8, v105, 0xbfb8aa3b
v_mul_f32 v120, v120, v102
v_mul_f32 v121, v121, v103
v_rcp_f32 v126, v126
v_rcp_f32 v127, v127
v_exp_f32 v106, v124
v_exp_f32 v107, v125
v_rcp_f32 v104, v104
v_rcp_f32 v105, v105
v_cvt_pk_bf16_f32 v28, v120, v121
v_mul_f32 v3, v110, v126
v_mul_f32 v4, v111, v127
v_mul_f32 v126, v7, v3
v_mul_f32 v127, v7, v4
v_fmac_f32 v126, v6, v109
v_fmac_f32 v127, v6, v3
v_fmac_f32 v126, v5, v108
v_fmac_f32 v127, v5, v109
v_fmaak_f32 v106, v8, v106, 0xbfb8aa3b
v_fmaak_f32 v107, v8, v107, 0xbfb8aa3b
v_mul_f32 v122, v122, v104
v_mul_f32 v123, v123, v105
v_exp_f32 v108, v126
v_exp_f32 v109, v127
v_rcp_f32 v106, v106
v_rcp_f32 v107, v107
v_cvt_pk_bf16_f32 v29, v122, v123
v_fmaak_f32 v108, v8, v108, 0xbfb8aa3b
v_fmaak_f32 v109, v8, v109, 0xbfb8aa3b
v_mul_f32 v124, v124, v106
v_mul_f32 v125, v125, v107
ds_read_b128 v[32:35], v0 offset:32768
ds_read_b128 v[36:39], v0 offset:49152
ds_read_b128 v[40:43], v1 offset:32768
ds_read_b128 v[44:47], v1 offset:49152
v_mov_b32 v9, v58
v_rcp_f32 v108, v108
v_rcp_f32 v109, v109
v_cvt_pk_bf16_f32 v30, v124, v125
v_mul_f32 v126, v126, v108
v_mul_f32 v127, v127, v109
v_cvt_pk_bf16_f32 v31, v126, v127
s_setprio 3
s_waitcnt lgkmcnt(3)
v_mfma_f32_32x32x16_bf16 v[80:95], v[32:35], v[192:195], 0
ds_write_b128 v2, v[16:19] offset:0
v_mfma_f32_32x32x16_bf16 v[64:79], v[32:35], v[128:131], 0
ds_read_b128 v[48:51], v0 offset:33024
s_waitcnt lgkmcnt(4)
v_mfma_f32_32x32x16_bf16 v[112:127], v[36:39], v[192:195], 0
ds_write_b128 v15, v[20:23] offset:0
v_mfma_f32_32x32x16_bf16 v[96:111], v[36:39], v[128:131], 0
ds_read_b128 v[52:55], v0 offset:49408
s_waitcnt lgkmcnt(5)
v_mfma_f32_32x32x16_bf16 v[80:95], v[40:43], v[196:199], v[80:95]
ds_write_b128 v2, v[24:27] offset:16384
v_mfma_f32_32x32x16_bf16 v[64:79], v[40:43], v[132:135], v[64:79]
ds_read_b128 v[32:35], v1 offset:33024
s_waitcnt lgkmcnt(6)
v_mfma_f32_32x32x16_bf16 v[112:127], v[44:47], v[196:199], v[112:127]
ds_write_b128 v15, v[28:31] offset:16384
v_mfma_f32_32x32x16_bf16 v[96:111], v[44:47], v[132:135], v[96:111]
ds_read_b128 v[36:39], v1 offset:49408
s_waitcnt lgkmcnt(6)
v_mfma_f32_32x32x16_bf16 v[80:95], v[48:51], v[200:203], v[80:95]
v_mfma_f32_32x32x16_bf16 v[64:79], v[48:51], v[136:139], v[64:79]
ds_read_b128 v[40:43], v0 offset:33280
s_waitcnt lgkmcnt(5)
v_mfma_f32_32x32x16_bf16 v[112:127], v[52:55], v[200:203], v[112:127]
v_mfma_f32_32x32x16_bf16 v[96:111], v[52:55], v[136:139], v[96:111]
ds_read_b128 v[44:47], v0 offset:49664
s_waitcnt lgkmcnt(4)
v_mfma_f32_32x32x16_bf16 v[80:95], v[32:35], v[204:207], v[80:95]
v_mfma_f32_32x32x16_bf16 v[64:79], v[32:35], v[140:143], v[64:79]
ds_read_b128 v[48:51], v1 offset:33280
s_waitcnt lgkmcnt(3)
v_mfma_f32_32x32x16_bf16 v[112:127], v[36:39], v[204:207], v[112:127]
v_mfma_f32_32x32x16_bf16 v[96:111], v[36:39], v[140:143], v[96:111]
ds_read_b128 v[52:55], v1 offset:49664
s_barrier
s_waitcnt lgkmcnt(3)
v_mfma_f32_32x32x16_bf16 v[80:95], v[40:43], v[208:211], v[80:95]
s_add_u32 m0, s36, 0
s_xor_b32 s37, s31, 65536
buffer_load_dwordx4 v9, s[16:19], s37 offen lds
v_mfma_f32_32x32x16_bf16 v[64:79], v[40:43], v[144:147], v[64:79]
ds_read_b128 v[32:35], v0 offset:33536
s_waitcnt lgkmcnt(3)
v_mfma_f32_32x32x16_bf16 v[112:127], v[44:47], v[208:211], v[112:127]
s_add_u32 m0, s36, 1024
s_xor_b32 s37, s31, 69632
buffer_load_dwordx4 v9, s[16:19], s37 offen lds
v_mfma_f32_32x32x16_bf16 v[96:111], v[44:47], v[144:147], v[96:111]
ds_read_b128 v[36:39], v0 offset:49920
s_waitcnt lgkmcnt(3)
v_mfma_f32_32x32x16_bf16 v[80:95], v[48:51], v[212:215], v[80:95]
s_add_u32 m0, s36, 2048
s_xor_b32 s37, s31, 73728
buffer_load_dwordx4 v9, s[16:19], s37 offen lds
v_mfma_f32_32x32x16_bf16 v[64:79], v[48:51], v[148:151], v[64:79]
ds_read_b128 v[40:43], v1 offset:33536
s_waitcnt lgkmcnt(3)
v_mfma_f32_32x32x16_bf16 v[112:127], v[52:55], v[212:215], v[112:127]
s_add_u32 m0, s36, 3072
s_xor_b32 s37, s31, 77824
buffer_load_dwordx4 v9, s[16:19], s37 offen lds
v_mfma_f32_32x32x16_bf16 v[96:111], v[52:55], v[148:151], v[96:111]
ds_read_b128 v[44:47], v1 offset:49920
s_waitcnt lgkmcnt(3)
v_mfma_f32_32x32x16_bf16 v[80:95], v[32:35], v[216:219], v[80:95]
s_add_u32 m0, s36, 4096
s_xor_b32 s37, s31, 81920
buffer_load_dwordx4 v9, s[16:19], s37 offen lds
v_mfma_f32_32x32x16_bf16 v[64:79], v[32:35], v[152:155], v[64:79]
ds_read_b128 v[48:51], v0 offset:33792
s_waitcnt lgkmcnt(3)
v_mfma_f32_32x32x16_bf16 v[112:127], v[36:39], v[216:219], v[112:127]
s_add_u32 m0, s36, 5120
s_xor_b32 s37, s31, 86016
buffer_load_dwordx4 v9, s[16:19], s37 offen lds
v_mfma_f32_32x32x16_bf16 v[96:111], v[36:39], v[152:155], v[96:111]
ds_read_b128 v[52:55], v0 offset:50176
s_waitcnt lgkmcnt(3)
v_mfma_f32_32x32x16_bf16 v[80:95], v[40:43], v[220:223], v[80:95]
s_add_u32 m0, s36, 6144
s_xor_b32 s37, s31, 90112
buffer_load_dwordx4 v9, s[16:19], s37 offen lds
v_mfma_f32_32x32x16_bf16 v[64:79], v[40:43], v[156:159], v[64:79]
ds_read_b128 v[32:35], v1 offset:33792
s_waitcnt lgkmcnt(3)
v_mfma_f32_32x32x16_bf16 v[112:127], v[44:47], v[220:223], v[112:127]
s_add_u32 m0, s36, 7168
s_xor_b32 s37, s31, 94208
buffer_load_dwordx4 v9, s[16:19], s37 offen lds
v_mfma_f32_32x32x16_bf16 v[96:111], v[44:47], v[156:159], v[96:111]
ds_read_b128 v[36:39], v1 offset:50176
s_waitcnt lgkmcnt(3)
v_mfma_f32_32x32x16_bf16 v[80:95], v[48:51], v[224:227], v[80:95]
s_add_u32 m0, s36, 8192
s_xor_b32 s37, s31, 98304
buffer_load_dwordx4 v9, s[16:19], s37 offen lds
v_mfma_f32_32x32x16_bf16 v[64:79], v[48:51], v[160:163], v[64:79]
ds_read_b128 v[40:43], v0 offset:34048
s_waitcnt lgkmcnt(3)
v_mfma_f32_32x32x16_bf16 v[112:127], v[52:55], v[224:227], v[112:127]
s_add_u32 m0, s36, 9216
s_xor_b32 s37, s31, 102400
buffer_load_dwordx4 v9, s[16:19], s37 offen lds
v_mfma_f32_32x32x16_bf16 v[96:111], v[52:55], v[160:163], v[96:111]
ds_read_b128 v[44:47], v0 offset:50432
s_waitcnt lgkmcnt(3)
v_mfma_f32_32x32x16_bf16 v[80:95], v[32:35], v[228:231], v[80:95]
s_add_u32 m0, s36, 10240
s_xor_b32 s37, s31, 106496
buffer_load_dwordx4 v9, s[16:19], s37 offen lds
v_mfma_f32_32x32x16_bf16 v[64:79], v[32:35], v[164:167], v[64:79]
ds_read_b128 v[48:51], v1 offset:34048
s_waitcnt lgkmcnt(3)
v_mfma_f32_32x32x16_bf16 v[112:127], v[36:39], v[228:231], v[112:127]
s_add_u32 m0, s36, 11264
s_xor_b32 s37, s31, 110592
buffer_load_dwordx4 v9, s[16:19], s37 offen lds
v_mfma_f32_32x32x16_bf16 v[96:111], v[36:39], v[164:167], v[96:111]
ds_read_b128 v[52:55], v1 offset:50432
s_waitcnt lgkmcnt(3)
v_mfma_f32_32x32x16_bf16 v[80:95], v[40:43], v[232:235], v[80:95]
s_add_u32 m0, s36, 12288
s_xor_b32 s37, s31, 114688
buffer_load_dwordx4 v9, s[16:19], s37 offen lds
v_mfma_f32_32x32x16_bf16 v[64:79], v[40:43], v[168:171], v[64:79]
ds_read_b128 v[32:35], v0 offset:34304
s_waitcnt lgkmcnt(3)
v_mfma_f32_32x32x16_bf16 v[112:127], v[44:47], v[232:235], v[112:127]
s_add_u32 m0, s36, 13312
s_xor_b32 s37, s31, 118784
buffer_load_dwordx4 v9, s[16:19], s37 offen lds
v_mfma_f32_32x32x16_bf16 v[96:111], v[44:47], v[168:171], v[96:111]
ds_read_b128 v[36:39], v0 offset:50688
s_waitcnt lgkmcnt(3)
v_mfma_f32_32x32x16_bf16 v[80:95], v[48:51], v[236:239], v[80:95]
s_add_u32 m0, s36, 14336
s_xor_b32 s37, s31, 122880
buffer_load_dwordx4 v9, s[16:19], s37 offen lds
v_mfma_f32_32x32x16_bf16 v[64:79], v[48:51], v[172:175], v[64:79]
ds_read_b128 v[40:43], v1 offset:34304
s_waitcnt lgkmcnt(3)
v_mfma_f32_32x32x16_bf16 v[112:127], v[52:55], v[236:239], v[112:127]
s_add_u32 m0, s36, 15360
s_xor_b32 s37, s31, 126976
buffer_load_dwordx4 v9, s[16:19], s37 offen lds
v_mfma_f32_32x32x16_bf16 v[96:111], v[52:55], v[172:175], v[96:111]
ds_read_b128 v[44:47], v1 offset:50688
s_waitcnt lgkmcnt(3)
v_mfma_f32_32x32x16_bf16 v[80:95], v[32:35], v[240:243], v[80:95]
v_mfma_f32_32x32x16_bf16 v[64:79], v[32:35], v[176:179], v[64:79]
ds_read_b128 v[48:51], v0 offset:34560
s_waitcnt lgkmcnt(3)
v_mfma_f32_32x32x16_bf16 v[112:127], v[36:39], v[240:243], v[112:127]
v_mfma_f32_32x32x16_bf16 v[96:111], v[36:39], v[176:179], v[96:111]
ds_read_b128 v[52:55], v0 offset:50944
s_waitcnt lgkmcnt(3)
v_mfma_f32_32x32x16_bf16 v[80:95], v[40:43], v[244:247], v[80:95]
v_mfma_f32_32x32x16_bf16 v[64:79], v[40:43], v[180:183], v[64:79]
ds_read_b128 v[32:35], v1 offset:34560
s_waitcnt lgkmcnt(3)
v_mfma_f32_32x32x16_bf16 v[112:127], v[44:47], v[244:247], v[112:127]
v_mfma_f32_32x32x16_bf16 v[96:111], v[44:47], v[180:183], v[96:111]
ds_read_b128 v[36:39], v1 offset:50944
s_waitcnt lgkmcnt(3)
v_mfma_f32_32x32x16_bf16 v[80:95], v[48:51], v[248:251], v[80:95]
v_mfma_f32_32x32x16_bf16 v[64:79], v[48:51], v[184:187], v[64:79]
s_waitcnt lgkmcnt(2)
v_mfma_f32_32x32x16_bf16 v[112:127], v[52:55], v[248:251], v[112:127]
v_mfma_f32_32x32x16_bf16 v[96:111], v[52:55], v[184:187], v[96:111]
s_waitcnt lgkmcnt(1)
v_mfma_f32_32x32x16_bf16 v[80:95], v[32:35], v[252:255], v[80:95]
s_nop 2
v_mfma_f32_32x32x16_bf16 v[64:79], v[32:35], v[188:191], v[64:79]
s_nop 1
s_waitcnt lgkmcnt(0)
v_mfma_f32_32x32x16_bf16 v[112:127], v[36:39], v[252:255], v[112:127]
s_nop 1
v_mfma_f32_32x32x16_bf16 v[96:111], v[36:39], v[188:191], v[96:111]
s_setprio 0
v_mul_f32 v80, v8, v80
v_mul_f32 v81, v8, v81
s_waitcnt vmcnt(0)
s_barrier
v_exp_f32 v80, v80
v_exp_f32 v81, v81
v_mul_f32 v82, v8, v82
v_mul_f32 v83, v8, v83
v_add_f32 v80, 1.0, v80
v_add_f32 v81, 1.0, v81
v_exp_f32 v82, v82
v_exp_f32 v83, v83
v_rcp_f32 v80, v80
v_rcp_f32 v81, v81
v_mul_f32 v84, v8, v84
v_mul_f32 v85, v8, v85
v_mul_f32 v64, v64, v80
v_mul_f32 v65, v65, v81
v_add_f32 v82, 1.0, v82
v_add_f32 v83, 1.0, v83
v_mul_f32 v80, v7, v64
v_mul_f32 v81, v7, v65
v_fmac_f32 v80, v6, v4
v_fmac_f32 v81, v6, v64
v_fmac_f32 v80, v5, v3
v_fmac_f32 v81, v5, v4
v_exp_f32 v84, v84
v_exp_f32 v85, v85
v_rcp_f32 v82, v82
v_rcp_f32 v83, v83
v_exp_f32 v3, v80
v_exp_f32 v4, v81
v_mul_f32 v86, v8, v86
v_mul_f32 v87, v8, v87
v_mul_f32 v66, v66, v82
v_mul_f32 v67, v67, v83
v_add_f32 v84, 1.0, v84
v_add_f32 v85, 1.0, v85
v_mul_f32 v82, v7, v66
v_mul_f32 v83, v7, v67
v_fmac_f32 v82, v6, v65
v_fmac_f32 v83, v6, v66
v_fmac_f32 v82, v5, v64
v_fmac_f32 v83, v5, v65
v_fmaak_f32 v3, v8, v3, 0xbfb8aa3b
v_fmaak_f32 v4, v8, v4, 0xbfb8aa3b
v_exp_f32 v86, v86
v_exp_f32 v87, v87
v_rcp_f32 v84, v84
v_rcp_f32 v85, v85
v_exp_f32 v64, v82
v_exp_f32 v65, v83
v_rcp_f32 v3, v3
v_rcp_f32 v4, v4
v_mul_f32 v88, v8, v88
v_mul_f32 v89, v8, v89
v_mul_f32 v68, v68, v84
v_mul_f32 v69, v69, v85
v_add_f32 v86, 1.0, v86
v_add_f32 v87, 1.0, v87
v_mul_f32 v84, v7, v68
v_mul_f32 v85, v7, v69
v_fmac_f32 v84, v6, v67
v_fmac_f32 v85, v6, v68
v_fmac_f32 v84, v5, v66
v_fmac_f32 v85, v5, v67
v_fmaak_f32 v64, v8, v64, 0xbfb8aa3b
v_fmaak_f32 v65, v8, v65, 0xbfb8aa3b
v_mul_f32 v80, v80, v3
v_mul_f32 v81, v81, v4
v_exp_f32 v88, v88
v_exp_f32 v89, v89
v_rcp_f32 v86, v86
v_rcp_f32 v87, v87
v_exp_f32 v66, v84
v_exp_f32 v67, v85
v_rcp_f32 v64, v64
v_rcp_f32 v65, v65
v_cvt_pk_bf16_f32 v80, v80, v81
v_mul_f32 v90, v8, v90
v_mul_f32 v91, v8, v91
v_mul_f32 v70, v70, v86
v_mul_f32 v71, v71, v87
v_add_f32 v88, 1.0, v88
v_add_f32 v89, 1.0, v89
v_mul_f32 v86, v7, v70
v_mul_f32 v87, v7, v71
v_fmac_f32 v86, v6, v69
v_fmac_f32 v87, v6, v70
v_fmac_f32 v86, v5, v68
v_fmac_f32 v87, v5, v69
v_fmaak_f32 v66, v8, v66, 0xbfb8aa3b
v_fmaak_f32 v67, v8, v67, 0xbfb8aa3b
v_mul_f32 v82, v82, v64
v_mul_f32 v83, v83, v65
v_exp_f32 v90, v90
v_exp_f32 v91, v91
v_rcp_f32 v88, v88
v_rcp_f32 v89, v89
v_exp_f32 v68, v86
v_exp_f32 v69, v87
v_rcp_f32 v66, v66
v_rcp_f32 v67, v67
v_cvt_pk_bf16_f32 v81, v82, v83
v_mul_f32 v92, v8, v92
v_mul_f32 v93, v8, v93
v_mul_f32 v72, v72, v88
v_mul_f32 v73, v73, v89
v_add_f32 v90, 1.0, v90
v_add_f32 v91, 1.0, v91
v_mul_f32 v88, v7, v72
v_mul_f32 v89, v7, v73
v_fmac_f32 v88, v6, v71
v_fmac_f32 v89, v6, v72
v_fmac_f32 v88, v5, v70
v_fmac_f32 v89, v5, v71
v_fmaak_f32 v68, v8, v68, 0xbfb8aa3b
v_fmaak_f32 v69, v8, v69, 0xbfb8aa3b
v_mul_f32 v84, v84, v66
v_mul_f32 v85, v85, v67
v_exp_f32 v92, v92
v_exp_f32 v93, v93
v_rcp_f32 v90, v90
v_rcp_f32 v91, v91
v_exp_f32 v70, v88
v_exp_f32 v71, v89
v_rcp_f32 v68, v68
v_rcp_f32 v69, v69
v_cvt_pk_bf16_f32 v82, v84, v85
v_mul_f32 v94, v8, v94
v_mul_f32 v95, v8, v95
v_mul_f32 v74, v74, v90
v_mul_f32 v75, v75, v91
v_add_f32 v92, 1.0, v92
v_add_f32 v93, 1.0, v93
v_mul_f32 v90, v7, v74
v_mul_f32 v91, v7, v75
v_fmac_f32 v90, v6, v73
v_fmac_f32 v91, v6, v74
v_fmac_f32 v90, v5, v72
v_fmac_f32 v91, v5, v73
v_fmaak_f32 v70, v8, v70, 0xbfb8aa3b
v_fmaak_f32 v71, v8, v71, 0xbfb8aa3b
v_mul_f32 v86, v86, v68
v_mul_f32 v87, v87, v69
v_exp_f32 v94, v94
v_exp_f32 v95, v95
v_rcp_f32 v92, v92
v_rcp_f32 v93, v93
v_exp_f32 v72, v90
v_exp_f32 v73, v91
v_rcp_f32 v70, v70
v_rcp_f32 v71, v71
v_cvt_pk_bf16_f32 v83, v86, v87
ds_write_b128 v2, v[80:83] offset:32768
v_mul_f32 v112, v8, v112
v_mul_f32 v113, v8, v113
v_mul_f32 v76, v76, v92
v_mul_f32 v77, v77, v93
v_add_f32 v94, 1.0, v94
v_add_f32 v95, 1.0, v95
v_mul_f32 v92, v7, v76
v_mul_f32 v93, v7, v77
v_fmac_f32 v92, v6, v75
v_fmac_f32 v93, v6, v76
v_fmac_f32 v92, v5, v74
v_fmac_f32 v93, v5, v75
v_fmaak_f32 v72, v8, v72, 0xbfb8aa3b
v_fmaak_f32 v73, v8, v73, 0xbfb8aa3b
v_mul_f32 v88, v88, v70
v_mul_f32 v89, v89, v71
v_exp_f32 v112, v112
v_exp_f32 v113, v113
v_rcp_f32 v94, v94
v_rcp_f32 v95, v95
v_exp_f32 v74, v92
v_exp_f32 v75, v93
v_rcp_f32 v72, v72
v_rcp_f32 v73, v73
v_cvt_pk_bf16_f32 v84, v88, v89
v_mul_f32 v114, v8, v114
v_mul_f32 v115, v8, v115
v_mul_f32 v78, v78, v94
v_mul_f32 v79, v79, v95
v_add_f32 v112, 1.0, v112
v_add_f32 v113, 1.0, v113
v_mul_f32 v94, v7, v78
v_mul_f32 v95, v7, v79
v_fmac_f32 v94, v6, v77
v_fmac_f32 v95, v6, v78
v_fmac_f32 v94, v5, v76
v_fmac_f32 v95, v5, v77
v_fmaak_f32 v74, v8, v74, 0xbfb8aa3b
v_fmaak_f32 v75, v8, v75, 0xbfb8aa3b
v_mul_f32 v90, v90, v72
v_mul_f32 v91, v91, v73
v_exp_f32 v114, v114
v_exp_f32 v115, v115
v_rcp_f32 v112, v112
v_rcp_f32 v113, v113
v_exp_f32 v76, v94
v_exp_f32 v77, v95
v_rcp_f32 v74, v74
v_rcp_f32 v75, v75
v_cvt_pk_bf16_f32 v85, v90, v91
s_setprio 1
v_mul_f32 v116, v8, v116
v_mul_f32 v117, v8, v117
v_mul_f32 v96, v96, v112
v_mul_f32 v97, v97, v113
v_add_f32 v114, 1.0, v114
v_add_f32 v115, 1.0, v115
v_mul_f32 v112, v7, v96
v_mul_f32 v113, v7, v97
v_fmac_f32 v112, v6, v79
v_fmac_f32 v113, v6, v96
v_fmac_f32 v112, v5, v78
v_fmac_f32 v113, v5, v79
v_fmaak_f32 v76, v8, v76, 0xbfb8aa3b
v_fmaak_f32 v77, v8, v77, 0xbfb8aa3b
v_mul_f32 v92, v92, v74
v_mul_f32 v93, v93, v75
v_exp_f32 v116, v116
v_exp_f32 v117, v117
v_rcp_f32 v114, v114
v_rcp_f32 v115, v115
v_exp_f32 v78, v112
v_exp_f32 v79, v113
v_rcp_f32 v76, v76
v_rcp_f32 v77, v77
v_cvt_pk_bf16_f32 v86, v92, v93
v_mul_f32 v118, v8, v118
v_mul_f32 v119, v8, v119
v_mul_f32 v98, v98, v114
v_mul_f32 v99, v99, v115
v_add_f32 v116, 1.0, v116
v_add_f32 v117, 1.0, v117
v_mul_f32 v114, v7, v98
v_mul_f32 v115, v7, v99
v_fmac_f32 v114, v6, v97
v_fmac_f32 v115, v6, v98
v_fmac_f32 v114, v5, v96
v_fmac_f32 v115, v5, v97
v_fmaak_f32 v78, v8, v78, 0xbfb8aa3b
v_fmaak_f32 v79, v8, v79, 0xbfb8aa3b
v_mul_f32 v94, v94, v76
v_mul_f32 v95, v95, v77
v_exp_f32 v118, v118
v_exp_f32 v119, v119
v_rcp_f32 v116, v116
v_rcp_f32 v117, v117
v_exp_f32 v96, v114
v_exp_f32 v97, v115
v_rcp_f32 v78, v78
v_rcp_f32 v79, v79
v_cvt_pk_bf16_f32 v87, v94, v95
ds_write_b128 v15, v[84:87] offset:32768
v_mul_f32 v120, v8, v120
v_mul_f32 v121, v8, v121
v_mul_f32 v100, v100, v116
v_mul_f32 v101, v101, v117
v_add_f32 v118, 1.0, v118
v_add_f32 v119, 1.0, v119
v_mul_f32 v116, v7, v100
v_mul_f32 v117, v7, v101
v_fmac_f32 v116, v6, v99
v_fmac_f32 v117, v6, v100
v_fmac_f32 v116, v5, v98
v_fmac_f32 v117, v5, v99
v_fmaak_f32 v96, v8, v96, 0xbfb8aa3b
v_fmaak_f32 v97, v8, v97, 0xbfb8aa3b
v_mul_f32 v112, v112, v78
v_mul_f32 v113, v113, v79
s_waitcnt lgkmcnt(0)
s_barrier
v_exp_f32 v120, v120
v_exp_f32 v121, v121
v_rcp_f32 v118, v118
v_rcp_f32 v119, v119
v_exp_f32 v98, v116
v_exp_f32 v99, v117
v_rcp_f32 v96, v96
v_rcp_f32 v97, v97
v_cvt_pk_bf16_f32 v112, v112, v113
v_mul_f32 v122, v8, v122
v_mul_f32 v123, v8, v123
v_mul_f32 v102, v102, v118
v_mul_f32 v103, v103, v119
v_add_f32 v120, 1.0, v120
v_add_f32 v121, 1.0, v121
v_mul_f32 v118, v7, v102
v_mul_f32 v119, v7, v103
v_fmac_f32 v118, v6, v101
v_fmac_f32 v119, v6, v102
v_fmac_f32 v118, v5, v100
v_fmac_f32 v119, v5, v101
v_fmaak_f32 v98, v8, v98, 0xbfb8aa3b
v_fmaak_f32 v99, v8, v99, 0xbfb8aa3b
v_mul_f32 v114, v114, v96
v_mul_f32 v115, v115, v97
v_exp_f32 v122, v122
v_exp_f32 v123, v123
v_rcp_f32 v120, v120
v_rcp_f32 v121, v121
v_exp_f32 v100, v118
v_exp_f32 v101, v119
v_rcp_f32 v98, v98
v_rcp_f32 v99, v99
v_cvt_pk_bf16_f32 v113, v114, v115
v_mul_f32 v124, v8, v124
v_mul_f32 v125, v8, v125
v_mul_f32 v104, v104, v120
v_mul_f32 v105, v105, v121
v_add_f32 v122, 1.0, v122
v_add_f32 v123, 1.0, v123
v_mul_f32 v120, v7, v104
v_mul_f32 v121, v7, v105
v_fmac_f32 v120, v6, v103
v_fmac_f32 v121, v6, v104
v_fmac_f32 v120, v5, v102
v_fmac_f32 v121, v5, v103
v_fmaak_f32 v100, v8, v100, 0xbfb8aa3b
v_fmaak_f32 v101, v8, v101, 0xbfb8aa3b
v_mul_f32 v116, v116, v98
v_mul_f32 v117, v117, v99
v_exp_f32 v124, v124
v_exp_f32 v125, v125
v_rcp_f32 v122, v122
v_rcp_f32 v123, v123
v_exp_f32 v102, v120
v_exp_f32 v103, v121
v_rcp_f32 v100, v100
v_rcp_f32 v101, v101
v_cvt_pk_bf16_f32 v114, v116, v117
v_mul_f32 v126, v8, v126
v_mul_f32 v127, v8, v127
v_mul_f32 v106, v106, v122
v_mul_f32 v107, v107, v123
v_add_f32 v124, 1.0, v124
v_add_f32 v125, 1.0, v125
v_mul_f32 v122, v7, v106
v_mul_f32 v123, v7, v107
v_fmac_f32 v122, v6, v105
v_fmac_f32 v123, v6, v106
v_fmac_f32 v122, v5, v104
v_fmac_f32 v123, v5, v105
v_fmaak_f32 v102, v8, v102, 0xbfb8aa3b
v_fmaak_f32 v103, v8, v103, 0xbfb8aa3b
v_mul_f32 v118, v118, v100
v_mul_f32 v119, v119, v101
v_exp_f32 v126, v126
v_exp_f32 v127, v127
v_rcp_f32 v124, v124
v_rcp_f32 v125, v125
v_exp_f32 v104, v122
v_exp_f32 v105, v123
v_rcp_f32 v102, v102
v_rcp_f32 v103, v103
v_cvt_pk_bf16_f32 v115, v118, v119
ds_write_b128 v2, v[112:115] offset:49152
v_mul_f32 v108, v108, v124
v_mul_f32 v109, v109, v125
v_add_f32 v126, 1.0, v126
v_add_f32 v127, 1.0, v127
v_mul_f32 v124, v7, v108
v_mul_f32 v125, v7, v109
v_fmac_f32 v124, v6, v107
v_fmac_f32 v125, v6, v108
v_fmac_f32 v124, v5, v106
v_fmac_f32 v125, v5, v107
v_fmaak_f32 v104, v8, v104, 0xbfb8aa3b
v_fmaak_f32 v105, v8, v105, 0xbfb8aa3b
v_mul_f32 v120, v120, v102
v_mul_f32 v121, v121, v103
v_rcp_f32 v126, v126
v_rcp_f32 v127, v127
v_exp_f32 v106, v124
v_exp_f32 v107, v125
v_rcp_f32 v104, v104
v_rcp_f32 v105, v105
v_cvt_pk_bf16_f32 v116, v120, v121
v_mul_f32 v3, v110, v126
v_mul_f32 v4, v111, v127
v_mul_f32 v126, v7, v3
v_mul_f32 v127, v7, v4
v_fmac_f32 v126, v6, v109
v_fmac_f32 v127, v6, v3
v_fmac_f32 v126, v5, v108
v_fmac_f32 v127, v5, v109
v_fmaak_f32 v106, v8, v106, 0xbfb8aa3b
v_fmaak_f32 v107, v8, v107, 0xbfb8aa3b
v_mul_f32 v122, v122, v104
v_mul_f32 v123, v123, v105
v_exp_f32 v108, v126
v_exp_f32 v109, v127
v_rcp_f32 v106, v106
v_rcp_f32 v107, v107
v_cvt_pk_bf16_f32 v117, v122, v123
v_fmaak_f32 v108, v8, v108, 0xbfb8aa3b
v_fmaak_f32 v109, v8, v109, 0xbfb8aa3b
v_mul_f32 v124, v124, v106
v_mul_f32 v125, v125, v107
v_rcp_f32 v108, v108
v_rcp_f32 v109, v109
v_cvt_pk_bf16_f32 v118, v124, v125
v_mul_f32 v126, v126, v108
v_mul_f32 v127, v127, v109
v_cvt_pk_bf16_f32 v119, v126, v127
ds_write_b128 v15, v[116:119] offset:49152
s_waitcnt lgkmcnt(0)
s_barrier
s_endpgm
L_done:
s_endpgm
.section .rodata,"a"
.p2align 6
.amdhsa_kernel standalone__conformer_conv_module__speech_kernel
  .amdhsa_next_free_vgpr 256
  .amdhsa_next_free_sgpr 102
  .amdhsa_accum_offset 256
  .amdhsa_group_segment_fixed_size 0
  .amdhsa_kernarg_size 56
  .amdhsa_user_sgpr_count 2
  .amdhsa_user_sgpr_kernarg_segment_ptr 1
  .amdhsa_system_sgpr_workgroup_id_x 1
.end_amdhsa_kernel
```
